```python
import torch

def _softmax(x, axis=-1):
    return torch.softmax(x, dim=axis)
def _gelu(x):
    return torch.nn.functional.gelu(x, approximate="tanh")
def _silu(x):
    return torch.nn.functional.silu(x)
def _sigmoid(x):
    return torch.sigmoid(x)
def _layernorm(x, axis=-1, eps=1e-5):
    m = x.mean(dim=axis, keepdim=True)
    v = x.var(dim=axis, keepdim=True, unbiased=False)
    return (x - m) / torch.sqrt(v + eps)
def _scatter_add(tgt, idx, src, axis=0):
    return tgt.clone().index_add_(axis, idx, src)
def _segment_sum(src, seg, n):
    out = torch.zeros((n,) + src.shape[1:], dtype=src.dtype)
    return out.index_add_(0, seg, src)
def _pad(x, pw):
    flat = tuple(v for pair in reversed(pw) for v in pair)
    return torch.nn.functional.pad(x, flat)

kernel_name = 'interleave_layers__gqa_block_cached__dense_activation_gelu__decode'

def setup_inputs():

    _w = (lambda a: (lambda t: t.to(torch.bfloat16) if t.is_floating_point() else t)(torch.as_tensor(a)))
    def _A_setup():
        B, Sq, D = 2, 1, 512
        Hq, Hkv, Sk, Dh = 32, 32, 4096, 128
        assert Hq % Hkv == 0, (Hq, Hkv)
        return {
            "x": _w((lambda *s: torch.randn(*s, dtype=torch.bfloat16) * 0.05)(B, Sq, D)),
            "k_cache": _w((lambda *s: torch.randn(*s, dtype=torch.bfloat16) * 0.8)(B, Hkv, Sk, Dh)),
            "v_cache": _w((lambda *s: torch.randn(*s, dtype=torch.bfloat16) * 1.6)(B, Hkv, Sk, Dh)),
            "wq": _w((lambda *s: torch.randn(*s, dtype=torch.bfloat16) * 0.8)(D, Hq * Dh) * (D ** -0.5)),
            "wo": _w((lambda *s: torch.randn(*s, dtype=torch.bfloat16) * 1.6)(Hq * Dh, D) * ((Hq * Dh) ** -0.5)),
        }
    _A_in = _A_setup()

    def _B_setup():
        B, S, D, F = 2, 1, 512, 1376
        return {
            "x": _w((lambda *s: torch.randn(*s, dtype=torch.bfloat16) * 0.05)(B, S, D)),
            "w1": _w((lambda *s: torch.randn(*s, dtype=torch.bfloat16) * 0.4)(D, F) * (D ** -0.5)),
            "b1": _w((lambda *s: torch.randn(*s, dtype=torch.bfloat16) * 0.4)(F) * 0.01),
            "w2": _w((lambda *s: torch.randn(*s, dtype=torch.bfloat16) * 0.4)(F, D) * (F ** -0.5)),
            "b2": _w((lambda *s: torch.randn(*s, dtype=torch.bfloat16) * 0.4)(D) * 0.01),
        }
    _B_in = _B_setup()

    return {
        "A_x": _A_in["x"],
        "A_k_cache": _A_in["k_cache"],
        "A_v_cache": _A_in["v_cache"],
        "A_wq": _A_in["wq"],
        "A_wo": _A_in["wo"],
        "B_x": _B_in["x"],
        "B_w1": _B_in["w1"],
        "B_b1": _B_in["b1"],
        "B_w2": _B_in["w2"],
        "B_b2": _B_in["b2"],
    }

def reference(A_x, A_k_cache, A_v_cache, A_wq, A_wo, B_x, B_w1, B_b1, B_w2, B_b2):
    def _A_ref(x, k_cache, v_cache, wq, wo):
        B, Sq, D = x.shape
        Hq, Dh = 32, 128
        Hkv = k_cache.shape[1]
        rep = Hq // Hkv
        q = (lambda x, *d: x.permute(*d))((x @ wq).reshape(B, Sq, Hq, Dh), 0, 2, 1, 3)
        k = (lambda x, n, axis: torch.repeat_interleave(x, n, dim=axis))(k_cache, rep, axis=1)
        v = (lambda x, n, axis: torch.repeat_interleave(x, n, dim=axis))(v_cache, rep, axis=1)
        scores = torch.einsum("bhqd,bhkd->bhqk", q, k) * (Dh ** -0.5)
        p = _softmax(scores, axis=-1)
        o = torch.einsum("bhqk,bhkd->bhqd", p, v)
        return (lambda x, *d: x.permute(*d))(o, 0, 2, 1, 3).reshape(B, Sq, Hq * Dh) @ wo

    def _B_ref(x, w1, b1, w2, b2):
        h = torch.einsum("bsd,df->bsf", x, w1) + b1
        h = _gelu(h)
        return torch.einsum("bsf,fd->bsd", h, w2) + b2

    x = A_x
    x = x + _A_ref(_layernorm(x, axis=-1), A_k_cache, A_v_cache, A_wq, A_wo)
    x = x + _B_ref(_layernorm(x, axis=-1), B_w1, B_b1, B_w2, B_b2)
    x = x + _A_ref(_layernorm(x, axis=-1), A_k_cache, A_v_cache, A_wq, A_wo)
    x = x + _B_ref(_layernorm(x, axis=-1), B_w1, B_b1, B_w2, B_b2)
    return x
```

```asm
; @launch grid=(256,1,1) block=(256,1,1) lds=163840
.amdgcn_target "amdgcn-amd-amdhsa--gfx950"
.text
.globl interleave_layers__gqa_block_cached__dense_activation_gelu__decode_kernel
.p2align 8
.type interleave_layers__gqa_block_cached__dense_activation_gelu__decode_kernel,@function
interleave_layers__gqa_block_cached__dense_activation_gelu__decode_kernel:
    s_cmp_ge_u32 s2, 256
    s_cbranch_scc1 L_exit
    s_load_dwordx16 s[76:91], s[0:1], 0
    s_load_dwordx8 s[92:99], s[0:1], 64
    s_load_dwordx2 s[100:101], s[0:1], 96
    v_lshrrev_b32 v1, 6, v0
    s_nop 0
    v_readfirstlane_b32 s3, v1
    v_and_b32 v0, 63, v0
    s_and_b32 s4, s2, 7
    s_lshr_b32 s5, s2, 3
    v_lshrrev_b32 v28, 4, v0
    v_and_b32 v29, 15, v0
    v_lshlrev_b32 v16, 4, v0
    v_xor_b32 v30, v28, v29
    v_xor_b32 v31, 0, v30
    v_lshlrev_b32 v31, 4, v31
    v_lshl_add_u32 v31, v28, 8, v31
    v_add_u32 v84, 0, v31
    v_xor_b32 v31, 4, v30
    v_lshlrev_b32 v31, 4, v31
    v_lshl_add_u32 v31, v28, 8, v31
    v_add_u32 v85, 1024, v31
    v_xor_b32 v31, 8, v30
    v_lshlrev_b32 v31, 4, v31
    v_lshl_add_u32 v31, v28, 8, v31
    v_add_u32 v86, 2048, v31
    v_xor_b32 v31, 12, v30
    v_lshlrev_b32 v31, 4, v31
    v_lshl_add_u32 v31, v28, 8, v31
    v_add_u32 v87, 3072, v31
    s_bfe_u32 s13, s5, 0x10002
    s_lshl_b32 s13, s13, 5
    s_lshl_b32 s14, s4, 2
    s_add_u32 s13, s13, s14
    s_lshr_b32 s14, s5, 3
    s_add_u32 s13, s13, s14
    s_lshl_b32 s13, s13, 4
    s_and_b32 s14, s5, 3
    s_lshl_b32 s14, s14, 2
    s_add_u32 s13, s13, s14
    s_add_u32 s13, s13, s3
    s_lshl_b32 s13, s13, 16
    s_lshl_b32 s19, s2, 2
    s_add_u32 s19, s19, s3
    s_mul_i32 s19, s19, 0x9E3779B1
    s_lshr_b32 s19, s19, 28
    s_lshl_b32 s19, s19, 12
    s_mul_i32 s12, s3, 36864
    s_add_u32 s12, s12, 13312
    s_mov_b32 s38, 65536
    s_mov_b32 s39, 0x20000
    s_waitcnt lgkmcnt(0)
    s_add_u32 s36, s78, s13
    s_addc_u32 s37, s79, 0
    s_add_u32 s14, s19, 0
    s_and_b32 s14, s14, 65535
    s_add_u32 m0, s12, 12288
    s_nop 0
    buffer_load_dwordx4 v84, s[36:39], s14 offen nt lds
    s_add_u32 m0, s12, 13312
    s_nop 0
    buffer_load_dwordx4 v85, s[36:39], s14 offen nt lds
    s_add_u32 m0, s12, 14336
    s_nop 0
    buffer_load_dwordx4 v86, s[36:39], s14 offen nt lds
    s_add_u32 m0, s12, 15360
    s_nop 0
    buffer_load_dwordx4 v87, s[36:39], s14 offen nt lds
    s_load_dword s79, s[100:101], 657408
    s_add_u32 s40, s80, s13
    s_addc_u32 s41, s81, 0
    s_mov_b32 s42, 65536
    s_mov_b32 s43, 0x20000
    s_mov_b32 s46, 4194304
    s_mov_b32 s47, 0x20000
    s_mov_b32 s50, 4194304
    s_mov_b32 s51, 0x20000
    s_mov_b32 s54, 1409024
    s_mov_b32 s55, 0x20000
    s_mov_b32 s58, 1409024
    s_mov_b32 s59, 0x20000
    s_mov_b32 s62, 657664
    s_mov_b32 s63, 0x20000
    s_mov_b32 s66, 2048
    s_mov_b32 s67, 0x20000
    s_mov_b32 s74, 2048
    s_mov_b32 s75, 0x20000
    s_mov_b64 s[60:61], s[100:101]
    s_mov_b64 s[64:65], s[76:77]
    s_mov_b64 s[44:45], s[82:83]
    s_mov_b64 s[48:49], s[84:85]
    s_mov_b64 s[52:53], s[88:89]
    s_mov_b64 s[56:57], s[92:93]
    s_mov_b64 s[72:73], s[96:97]
    s_cmp_lg_u32 s3, 0
    s_cbranch_scc1 L_noclear
    v_mov_b32 v32, -1
    v_mov_b32 v33, -1
    v_mov_b32 v34, -1
    v_mov_b32 v35, -1
    s_lshl_b32 s14, s2, 11
    buffer_store_dwordx4 v[32:35], v16, s[60:63], s14 offen sc1
    buffer_store_dwordx4 v[32:35], v16, s[60:63], s14 offen offset:1024 sc1
L_noclear:
    v_bfe_u32 v30, v0, 3, 2
    v_lshrrev_b32 v31, 5, v0
    v_lshl_add_u32 v30, v30, 1, v31
    v_bfe_u32 v31, v0, 1, 2
    v_lshl_add_u32 v30, v30, 2, v31
    v_and_b32 v31, 1, v0
    v_lshlrev_b32 v31, 4, v31
    s_movk_i32 s15, 8192
    v_mad_u32_u24 v92, v30, s15, v31
    s_movk_i32 s15, 1024
    v_mad_u32_u24 v93, v30, s15, v31
    s_movk_i32 s15, 2752
    v_mad_u32_u24 v94, v30, s15, v31
    s_lshl_b32 s13, s3, 20
    s_lshl_b32 s14, s4, 10
    s_add_u32 s13, s13, s14
    s_lshl_b32 s14, s5, 5
    s_add_u32 s86, s13, s14
    s_add_u32 m0, s12, 0
    s_nop 0
    buffer_load_dwordx4 v92, s[44:47], s86 offen lds
    v_bfe_u32 v30, v0, 4, 1
    v_lshlrev_b32 v31, 1, v29
    s_movk_i32 s15, 1024
    v_mad_u32_u24 v6, v30, s15, v31
    s_movk_i32 s15, 384
    v_mad_u32_u24 v8, v30, s15, v31
    v_bfe_u32 v32, v0, 2, 2
    v_bfe_u32 v33, v0, 1, 1
    v_lshl_add_u32 v32, v33, 2, v32
    v_lshlrev_b32 v32, 2, v32
    s_movk_i32 s15, 256
    v_mad_u32_u24 v7, v30, s15, v32
    v_add_u32 v14, v31, v30
    v_lshlrev_b32 v14, 2, v14
    v_mul_u32_u24 v20, 272, v30
    v_lshlrev_b32 v21, 4, v30
    v_lshlrev_b32 v19, 4, v29
    v_and_b32 v32, 3, v0
    v_lshl_add_u32 v32, v30, 2, v32
    v_lshlrev_b32 v10, 3, v32
    v_bfe_u32 v32, v0, 1, 3
    v_lshl_add_u32 v32, v32, 2, v28
    v_lshlrev_b32 v32, 4, v32
    v_and_b32 v33, 1, v0
    s_movk_i32 s15, 1024
    v_mad_u32_u24 v5, v33, s15, v32
    s_movk_i32 s15, 384
    v_mad_u32_u24 v12, v33, s15, v32
    v_mov_b32 v36, 0x3f803f80
    v_mov_b32 v37, 0x3f803f80
    v_mov_b32 v38, 0x3f803f80
    v_mov_b32 v39, 0x3f803f80
    v_mov_b32 v40, 0x3f803f80
    v_mov_b32 v41, 0x3f803f80
    v_mov_b32 v42, 0x3f803f80
    v_mov_b32 v43, 0x3f803f80
    v_cmp_gt_u32 s[26:27], 8, v29
    v_cmp_gt_u32 s[28:29], 4, v29
    s_mov_b64 s[20:21], -1
    s_add_u32 s18, s5, 8
    s_and_b32 s18, s18, 31
    s_add_u32 s81, s5, 16
    s_and_b32 s81, s81, 31
    s_lshl_b32 s13, s3, 8
    s_mov_b64 exec, s[26:27]
    buffer_load_dwordx4 v[36:39], v5, s[64:67], s13 offen
    s_mov_b64 exec, s[20:21]
    s_sub_u32 s13, s5, 11
    s_cmp_lt_u32 s5, 16
    s_cselect_b32 s70, s5, s13
    s_mul_i32 s13, s3, 21
    s_add_u32 s70, s70, s13
    s_sub_u32 s13, s5, 16
    s_cmp_lt_u32 s13, 11
    s_cselect_b32 s70, 63, s70
    s_lshl_b32 s71, s70, 10
    s_add_u32 s71, s71, 393216
    s_lshl_b32 s13, s70, 5
    buffer_load_ushort v4, v6, s[64:67], s13 offen
    s_mov_b64 s[64:65], s[94:95]
    s_mov_b32 s66, 1024
    buffer_load_ushort v3, v31, s[64:67], s13 offen
    s_mul_i32 s87, s4, 11
    s_max_u32 s13, s4, 6
    s_sub_u32 s13, s13, 6
    s_sub_u32 s87, s87, s13
    s_sub_u32 s88, s5, 16
    s_cmp_lt_u32 s4, 6
    s_cselect_b32 s13, 11, 10
    s_mov_b32 s35, 0x03ff03ff
    s_cselect_b32 s34, 0x0fff0fff, s35
    s_cmp_lt_u32 s88, s13
    s_cselect_b32 s80, 1, 0
    s_add_u32 s89, s87, s88
    s_lshl_b32 s89, s89, 5
    s_mov_b64 s[64:65], s[90:91]
    s_mov_b32 s66, 2752
    buffer_load_ushort v2, v31, s[64:67], s89 offen
    s_add_u32 s14, s19, 4096
    s_and_b32 s14, s14, 65535
    s_add_u32 m0, s12, 16384
    s_nop 0
    buffer_load_dwordx4 v84, s[36:39], s14 offen nt lds
    s_add_u32 m0, s12, 17408
    s_nop 0
    buffer_load_dwordx4 v85, s[36:39], s14 offen nt lds
    s_add_u32 m0, s12, 18432
    s_nop 0
    buffer_load_dwordx4 v86, s[36:39], s14 offen nt lds
    s_add_u32 m0, s12, 19456
    s_nop 0
    buffer_load_dwordx4 v87, s[36:39], s14 offen nt lds
    s_add_u32 s13, s86, 262144
    s_add_u32 m0, s12, 1024
    s_nop 0
    buffer_load_dwordx4 v92, s[44:47], s13 offen lds
    s_lshr_b32 s13, s5, 2
    s_cmp_eq_u32 s13, 3
    s_cselect_b32 s8, 1, 0
    s_lshr_b32 s13, s18, 2
    s_cmp_eq_u32 s13, 3
    s_cselect_b32 s8, 1, s8
    v_and_b32 v32, 7, v0
    v_bfe_u32 v33, v0, 3, 1
    v_lshl_add_u32 v32, v32, 2, v33
    v_lshl_add_u32 v32, v32, 2, v28
    v_lshlrev_b32 v9, 4, v32
    v_bfe_u32 v32, v0, 1, 1
    v_lshl_add_u32 v32, v32, 2, v28
    v_and_b32 v33, 1, v0
    v_lshl_add_u32 v32, v32, 1, v33
    v_lshlrev_b32 v11, 4, v32
    v_mov_b32 v34, 0xeeee
    v_mov_b32 v35, 0x4444
    v_cmp_eq_u32 vcc, 1, v33
    s_nop 1
    v_cndmask_b32 v23, v35, v34, vcc
    v_cmp_gt_u32 vcc, 2, v29
    s_nop 1
    v_cndmask_b32 v26, 0, -1, vcc
    s_lshl_b32 s13, s3, 9
    s_add_u32 s13, s13, 2560
    v_lshl_add_u32 v32, v28, 1, v33
    v_lshl_add_u32 v25, v32, 4, s13
    v_lshrrev_b32 v32, 5, v0
    v_bfe_u32 v34, v0, 4, 1
    v_lshl_add_u32 v32, v32, 1, v34
    v_bfe_u32 v34, v0, 1, 1
    v_lshl_add_u32 v32, v32, 1, v34
    v_bfe_u32 v34, v0, 2, 1
    v_lshl_add_u32 v32, v32, 1, v34
    v_lshl_add_u32 v32, v32, 1, v33
    v_bfe_u32 v34, v0, 3, 1
    v_lshl_add_u32 v32, v32, 1, v34
    v_lshl_add_u32 v24, v32, 2, s13
    v_lshlrev_b32 v13, 2, v0
    v_lshlrev_b32 v15, 3, v0
    s_lshl_b32 s13, s3, 2
    v_lshl_add_u32 v17, v0, 4, s13
    s_lshl_b32 s13, s3, 9
    v_lshl_add_u32 v18, v0, 5, s13
    v_lshl_add_u32 v1, v0, 3, s12
    v_lshl_add_u32 v22, v0, 4, s12
    v_lshlrev_b32 v32, 8, v29
    v_add_u32 v32, s12, v32
    v_xor_b32 v33, v28, v29
    v_xor_b32 v34, 0, v33
    v_lshl_add_u32 v88, v34, 4, v32
    v_xor_b32 v34, 4, v33
    v_lshl_add_u32 v89, v34, 4, v32
    v_xor_b32 v34, 8, v33
    v_lshl_add_u32 v90, v34, 4, v32
    v_xor_b32 v34, 12, v33
    v_lshl_add_u32 v91, v34, 4, v32
    s_getreg_b32 s13, hwreg(HW_REG_XCC_ID, 0, 4)
    s_waitcnt lgkmcnt(0)
    s_and_b32 s79, s79, -16
    s_add_u32 s79, s79, 16
    s_or_b32 s79, s79, s13
    s_cmp_lg_u32 s3, 0
    s_cbranch_scc1 L_noflag
    s_lshl_b32 s13, s4, 7
    s_lshl_b32 s14, s5, 2
    s_add_u32 s13, s13, s14
    s_add_u32 s13, s13, 655360
    v_mov_b32 v32, s79
    s_waitcnt vmcnt(10)
    s_mov_b64 exec, 1
    buffer_store_dword v32, v13, s[60:63], s13 offen sc1
    s_mov_b64 exec, s[20:21]
L_noflag:
    s_mov_b32 s78, 0x3e0293ee
    s_mov_b32 s82, 0xc0135761
    s_mov_b32 s83, 0xbdd2d3e8
    s_mov_b32 s84, 0x3b000000
    s_mov_b32 s85, 0x3727c5ac
    s_mov_b32 s16, 0x05040100
    s_mov_b32 s17, 0x07060302
    s_mov_b32 s22, -1
    s_mov_b32 s23, 0
    s_mov_b32 s24, 0x55555555
    s_mov_b32 s25, 0
    s_mov_b32 s30, 0xffff
    s_mov_b32 s31, 0xffff
    s_mov_b64 s[32:33], 1
    s_mov_b32 s76, 0xffff
    s_mov_b32 s77, 0
    s_mul_i32 s6, s4, 49152
    s_lshl_b32 s7, s18, 10
    s_add_u32 s7, s7, 393216
    s_mov_b32 s10, 0
    s_mov_b32 s11, 400000
    s_mov_b32 s9, 1
    s_add_u32 s14, s19, 8192
    s_and_b32 s14, s14, 65535
    s_waitcnt vmcnt(5)
    s_add_u32 m0, s12, 20480
    s_nop 0
    buffer_load_dwordx4 v84, s[36:39], s14 offen nt lds
    s_waitcnt vmcnt(5)
    s_add_u32 m0, s12, 21504
    s_nop 0
    buffer_load_dwordx4 v85, s[36:39], s14 offen nt lds
    s_waitcnt vmcnt(5)
    s_add_u32 m0, s12, 22528
    s_nop 0
    buffer_load_dwordx4 v86, s[36:39], s14 offen nt lds
    s_waitcnt vmcnt(5)
    s_add_u32 m0, s12, 23552
    s_nop 0
    buffer_load_dwordx4 v87, s[36:39], s14 offen nt lds
    s_waitcnt vmcnt(14)
    ds_read_b128 a[0:3], v88 offset:12288
    ds_read_b128 a[4:7], v89 offset:12288
    ds_read_b128 a[8:11], v90 offset:12288
    ds_read_b128 a[12:15], v91 offset:12288
    s_add_u32 s13, s86, 524288
    s_add_u32 m0, s12, 2048
    s_nop 0
    buffer_load_dwordx4 v92, s[44:47], s13 offen lds
    s_add_u32 s14, s19, 12288
    s_and_b32 s14, s14, 65535
    s_waitcnt vmcnt(5)
    s_add_u32 m0, s12, 24576
    s_nop 0
    buffer_load_dwordx4 v84, s[36:39], s14 offen nt lds
    s_waitcnt vmcnt(5)
    s_add_u32 m0, s12, 25600
    s_nop 0
    buffer_load_dwordx4 v85, s[36:39], s14 offen nt lds
    s_waitcnt vmcnt(5)
    s_add_u32 m0, s12, 26624
    s_nop 0
    buffer_load_dwordx4 v86, s[36:39], s14 offen nt lds
    s_waitcnt vmcnt(5)
    s_add_u32 m0, s12, 27648
    s_nop 0
    buffer_load_dwordx4 v87, s[36:39], s14 offen nt lds
    s_waitcnt vmcnt(10)
    ds_read_b128 a[16:19], v88 offset:16384
    ds_read_b128 a[20:23], v89 offset:16384
    ds_read_b128 a[24:27], v90 offset:16384
    ds_read_b128 a[28:31], v91 offset:16384
    s_add_u32 s13, s86, 786432
    s_add_u32 m0, s12, 3072
    s_nop 0
    buffer_load_dwordx4 v92, s[44:47], s13 offen lds
    s_lshl_b32 s13, s4, 19
    s_lshl_b32 s14, s3, 17
    s_add_u32 s13, s13, s14
    s_lshl_b32 s14, s18, 5
    s_add_u32 s86, s13, s14
    s_mov_b32 s68, s86
    s_add_u32 s14, s19, 16384
    s_and_b32 s14, s14, 65535
    s_add_u32 m0, s12, 28672
    s_nop 0
    buffer_load_dwordx4 v84, s[36:39], s14 offen nt lds
    s_add_u32 m0, s12, 29696
    s_nop 0
    buffer_load_dwordx4 v85, s[36:39], s14 offen nt lds
    s_add_u32 m0, s12, 30720
    s_nop 0
    buffer_load_dwordx4 v86, s[36:39], s14 offen nt lds
    s_add_u32 m0, s12, 31744
    s_nop 0
    buffer_load_dwordx4 v87, s[36:39], s14 offen nt lds
    s_waitcnt vmcnt(10)
    ds_read_b128 a[32:35], v88 offset:20480
    ds_read_b128 a[36:39], v89 offset:20480
    ds_read_b128 a[40:43], v90 offset:20480
    ds_read_b128 a[44:47], v91 offset:20480
    s_add_u32 m0, s12, 4096
    s_nop 0
    buffer_load_dwordx4 v93, s[48:51], s68 offen lds
    s_add_u32 s14, s19, 20480
    s_and_b32 s14, s14, 65535
    s_add_u32 m0, s12, 32768
    s_nop 0
    buffer_load_dwordx4 v84, s[36:39], s14 offen nt lds
    s_add_u32 m0, s12, 33792
    s_nop 0
    buffer_load_dwordx4 v85, s[36:39], s14 offen nt lds
    s_add_u32 m0, s12, 34816
    s_nop 0
    buffer_load_dwordx4 v86, s[36:39], s14 offen nt lds
    s_add_u32 m0, s12, 35840
    s_nop 0
    buffer_load_dwordx4 v87, s[36:39], s14 offen nt lds
    s_waitcnt vmcnt(10)
    ds_read_b128 a[48:51], v88 offset:24576
    ds_read_b128 a[52:55], v89 offset:24576
    ds_read_b128 a[56:59], v90 offset:24576
    ds_read_b128 a[60:63], v91 offset:24576
    s_waitcnt vmcnt(9)
    v_lshlrev_b32 v4, 16, v4
    v_lshlrev_b32 v2, 16, v2
    v_lshlrev_b32 v3, 16, v3
    v_mov_b32 v28, v36
    v_mov_b32 v29, v37
    v_mov_b32 v30, v38
    v_mov_b32 v31, v39
    v_mov_b32 v32, v40
    v_mov_b32 v33, v41
    v_mov_b32 v34, v42
    v_mov_b32 v35, v43
    v_mov_b32 v76, 0x3f803f80
    v_mov_b32 v77, 0x3f803f80
    v_mov_b32 v78, 0x3f803f80
    v_mov_b32 v79, 0x3f803f80
    ds_read_b64_tr_b16 v[44:45], v1 offset:0
    ds_read_b64_tr_b16 v[46:47], v1 offset:512
    ds_read_b64_tr_b16 v[48:49], v1 offset:1024
    ds_read_b64_tr_b16 v[50:51], v1 offset:1536
    ds_read_b64_tr_b16 v[52:53], v1 offset:2048
    ds_read_b64_tr_b16 v[54:55], v1 offset:2560
    ds_read_b64_tr_b16 v[56:57], v1 offset:3072
    ds_read_b64_tr_b16 v[58:59], v1 offset:3584
    s_waitcnt lgkmcnt(0)
    v_mfma_f32_16x16x32_bf16 v[40:43], v[28:31], v[44:47], 0
    v_mfma_f32_16x16x32_bf16 v[36:39], v[28:31], v[28:31], 0
    v_mov_b32_dpp v32, v28 row_shl:2 row_mask:0xf bank_mask:0xf
    v_mov_b32_dpp v33, v29 row_shl:2 row_mask:0xf bank_mask:0xf
    v_mov_b32_dpp v34, v30 row_shl:2 row_mask:0xf bank_mask:0xf
    v_mov_b32_dpp v35, v31 row_shl:2 row_mask:0xf bank_mask:0xf
    v_mov_b32_dpp v76, v28 row_shl:4 row_mask:0xf bank_mask:0xf
    v_mov_b32_dpp v77, v29 row_shl:4 row_mask:0xf bank_mask:0xf
    v_mfma_f32_16x16x32_bf16 v[40:43], v[32:35], v[48:51], v[40:43]
    v_mov_b32_dpp v78, v30 row_shl:4 row_mask:0xf bank_mask:0xf
    v_mov_b32_dpp v79, v31 row_shl:4 row_mask:0xf bank_mask:0xf
    v_mfma_f32_16x16x32_bf16 v[36:39], v[32:35], v[32:35], v[36:39]
    v_mov_b32_dpp v32, v28 row_shl:6 row_mask:0xf bank_mask:0xf
    v_mov_b32_dpp v33, v29 row_shl:6 row_mask:0xf bank_mask:0xf
    v_mov_b32_dpp v34, v30 row_shl:6 row_mask:0xf bank_mask:0xf
    v_mov_b32_dpp v35, v31 row_shl:6 row_mask:0xf bank_mask:0xf
    v_mfma_f32_16x16x32_bf16 v[40:43], v[76:79], v[52:55], v[40:43]
    v_mfma_f32_16x16x32_bf16 v[36:39], v[76:79], v[76:79], v[36:39]
    v_mfma_f32_16x16x32_bf16 v[40:43], v[32:35], v[56:59], v[40:43]
    v_mfma_f32_16x16x32_bf16 v[36:39], v[32:35], v[32:35], v[36:39]
    s_mov_b64 exec, s[30:31]
    s_nop 5
    ds_write2st64_b32 v17, v40, v41 offset0:0 offset1:1
    ds_write2st64_b32 v17, v36, v37 offset0:4 offset1:5
    s_mov_b64 exec, s[20:21]
    s_waitcnt lgkmcnt(0)
    s_barrier
    s_cmp_lg_u32 s3, 0
    s_cbranch_scc1 L_q1nf
    ds_read_b128 v[68:71], v20 offset:1024
    ds_read_b128 v[72:75], v21 offset:1536
    ds_read_b128 v[60:63], v16
    ds_read_b128 v[64:67], v19 offset:512
    v_mov_b32 v44, s85
    s_waitcnt lgkmcnt(2)
    v_pk_add_f32 v[68:69], v[68:69], v[70:71]
    v_pk_add_f32 v[72:73], v[72:73], v[74:75]
    v_add_f32 v68, v68, v69
    v_add_f32 v72, v72, v73
    v_mul_f32 v72, s84, v72
    v_fma_f32 v68, v68, s84, v44
    v_fma_f32 v68, -v72, v72, v68
    v_max_f32 v68, s85, v68
    v_rsq_f32 v68, v68
    s_waitcnt lgkmcnt(0)
    v_pk_add_f32 v[60:61], v[60:61], v[62:63]
    v_pk_add_f32 v[64:65], v[64:65], v[66:67]
    v_add_f32 v60, v60, v61
    v_add_f32 v64, v64, v65
    v_fma_f32 v60, -v72, v64, v60
    v_mul_f32 v60, v60, v68
    s_nop 1
    v_mov_b32_dpp v27, v60 quad_perm:[1,1,3,3] row_mask:0xf bank_mask:0xf
    v_cvt_pk_bf16_f32 v27, v60, v27
    v_min_u32 v27, -2, v27
L_q1nf:
    s_waitcnt lgkmcnt(4)
    s_add_u32 s14, s19, 24576
    s_and_b32 s14, s14, 65535
    s_waitcnt vmcnt(5)
    s_add_u32 m0, s12, 12288
    s_nop 0
    buffer_load_dwordx4 v84, s[36:39], s14 offen nt lds
    s_waitcnt vmcnt(5)
    s_add_u32 m0, s12, 13312
    s_nop 0
    buffer_load_dwordx4 v85, s[36:39], s14 offen nt lds
    s_waitcnt vmcnt(5)
    s_add_u32 m0, s12, 14336
    s_nop 0
    buffer_load_dwordx4 v86, s[36:39], s14 offen nt lds
    s_waitcnt vmcnt(5)
    s_add_u32 m0, s12, 15360
    s_nop 0
    buffer_load_dwordx4 v87, s[36:39], s14 offen nt lds
    s_waitcnt vmcnt(9)
    ds_read_b128 a[64:67], v88 offset:28672
    ds_read_b128 a[68:71], v89 offset:28672
    ds_read_b128 a[72:75], v90 offset:28672
    ds_read_b128 a[76:79], v91 offset:28672
    s_add_u32 s13, s68, 32768
    s_add_u32 m0, s12, 5120
    s_nop 0
    buffer_load_dwordx4 v93, s[48:51], s13 offen lds
    s_mov_b32 s88, 655360
    buffer_load_dwordx4 v[28:31], v16, s[60:63], s88 offen sc1
    s_waitcnt lgkmcnt(4)
    s_add_u32 s14, s19, 28672
    s_and_b32 s14, s14, 65535
    s_waitcnt vmcnt(5)
    s_add_u32 m0, s12, 16384
    s_nop 0
    buffer_load_dwordx4 v84, s[36:39], s14 offen nt lds
    s_waitcnt vmcnt(5)
    s_add_u32 m0, s12, 17408
    s_nop 0
    buffer_load_dwordx4 v85, s[36:39], s14 offen nt lds
    s_waitcnt vmcnt(5)
    s_add_u32 m0, s12, 18432
    s_nop 0
    buffer_load_dwordx4 v86, s[36:39], s14 offen nt lds
    s_waitcnt vmcnt(5)
    s_add_u32 m0, s12, 19456
    s_nop 0
    buffer_load_dwordx4 v87, s[36:39], s14 offen nt lds
    s_waitcnt vmcnt(10)
    ds_read_b128 a[80:83], v88 offset:32768
    ds_read_b128 a[84:87], v89 offset:32768
    ds_read_b128 a[88:91], v90 offset:32768
    ds_read_b128 a[92:95], v91 offset:32768
    s_waitcnt vmcnt(4)
    v_xor_b32 v28, s79, v28
    v_xor_b32 v29, s79, v29
    v_xor_b32 v30, s79, v30
    v_xor_b32 v31, s79, v31
    v_or3_b32 v28, v28, v29, v30
    v_or_b32 v28, v28, v31
    v_cmp_lt_u32 vcc, 15, v28
    s_cbranch_vccz L_flagok
L_flagpoll:
    s_sleep 8
    buffer_load_dwordx4 v[28:31], v16, s[60:63], s88 offen sc1
    s_sub_u32 s11, s11, 1
    s_cbranch_scc1 L_abort
    s_waitcnt vmcnt(0)
    v_xor_b32 v28, s79, v28
    v_xor_b32 v29, s79, v29
    v_xor_b32 v30, s79, v30
    v_xor_b32 v31, s79, v31
    v_or3_b32 v28, v28, v29, v30
    v_or_b32 v28, v28, v31
    v_cmp_lt_u32 vcc, 15, v28
    s_cbranch_vccnz L_flagpoll
L_flagok:
    v_cmp_ne_u32 vcc, 0, v28
    s_lshl_b32 s13, s4, 3
    s_nop 0
    s_lshr_b64 vcc, vcc, s13
    s_and_b32 s9, vcc_lo, 0xff
    s_cmp_lg_u32 s3, 0
    s_cbranch_scc1 L_q1np
    s_lshr_b32 s13, s5, 3
    s_lshl_b32 s13, s13, 9
    s_and_b32 s14, s5, 7
    s_lshl_b32 s14, s14, 5
    s_add_u32 s13, s13, s14
    s_add_u32 s13, s13, s6
    s_mov_b64 exec, s[24:25]
    s_cmp_lg_u32 s9, 0
    s_cbranch_scc1 L_slow_1
    buffer_store_dword v27, v7, s[60:63], s13 offen
L_pubd_2:
    s_mov_b64 exec, s[20:21]
L_q1np:
    s_waitcnt lgkmcnt(4)
    s_add_u32 s14, s19, 32768
    s_and_b32 s14, s14, 65535
    s_waitcnt vmcnt(5)
    s_add_u32 m0, s12, 20480
    s_nop 0
    buffer_load_dwordx4 v84, s[36:39], s14 offen nt lds
    s_waitcnt vmcnt(5)
    s_add_u32 m0, s12, 21504
    s_nop 0
    buffer_load_dwordx4 v85, s[36:39], s14 offen nt lds
    s_waitcnt vmcnt(5)
    s_add_u32 m0, s12, 22528
    s_nop 0
    buffer_load_dwordx4 v86, s[36:39], s14 offen nt lds
    s_waitcnt vmcnt(5)
    s_add_u32 m0, s12, 23552
    s_nop 0
    buffer_load_dwordx4 v87, s[36:39], s14 offen nt lds
    s_waitcnt vmcnt(10)
    ds_read_b128 a[96:99], v88 offset:12288
    ds_read_b128 a[100:103], v89 offset:12288
    ds_read_b128 a[104:107], v90 offset:12288
    ds_read_b128 a[108:111], v91 offset:12288
    s_add_u32 s13, s68, 65536
    s_add_u32 m0, s12, 6144
    s_nop 0
    buffer_load_dwordx4 v93, s[48:51], s13 offen lds
    s_waitcnt lgkmcnt(4)
    s_add_u32 s14, s19, 36864
    s_and_b32 s14, s14, 65535
    s_waitcnt vmcnt(5)
    s_add_u32 m0, s12, 24576
    s_nop 0
    buffer_load_dwordx4 v84, s[36:39], s14 offen nt lds
    s_waitcnt vmcnt(5)
    s_add_u32 m0, s12, 25600
    s_nop 0
    buffer_load_dwordx4 v85, s[36:39], s14 offen nt lds
    s_waitcnt vmcnt(5)
    s_add_u32 m0, s12, 26624
    s_nop 0
    buffer_load_dwordx4 v86, s[36:39], s14 offen nt lds
    s_waitcnt vmcnt(5)
    s_add_u32 m0, s12, 27648
    s_nop 0
    buffer_load_dwordx4 v87, s[36:39], s14 offen nt lds
    s_waitcnt vmcnt(9)
    ds_read_b128 a[112:115], v88 offset:16384
    ds_read_b128 a[116:119], v89 offset:16384
    ds_read_b128 a[120:123], v90 offset:16384
    ds_read_b128 a[124:127], v91 offset:16384
    s_add_u32 s13, s68, 98304
    s_add_u32 m0, s12, 7168
    s_nop 0
    buffer_load_dwordx4 v93, s[48:51], s13 offen lds
    s_lshl_b32 s13, s87, 14
    s_lshl_b32 s14, s3, 16
    s_add_u32 s13, s13, s14
    s_lshl_b32 s14, s81, 5
    s_add_u32 s86, s13, s14
    s_mov_b32 s66, s86
    s_mul_i32 s13, s3, 352256
    s_add_u32 s67, s13, s89
    s_waitcnt lgkmcnt(4)
    s_add_u32 s14, s19, 40960
    s_and_b32 s14, s14, 65535
    s_waitcnt vmcnt(5)
    s_add_u32 m0, s12, 28672
    s_nop 0
    buffer_load_dwordx4 v84, s[36:39], s14 offen nt lds
    s_waitcnt vmcnt(5)
    s_add_u32 m0, s12, 29696
    s_nop 0
    buffer_load_dwordx4 v85, s[36:39], s14 offen nt lds
    s_waitcnt vmcnt(5)
    s_add_u32 m0, s12, 30720
    s_nop 0
    buffer_load_dwordx4 v86, s[36:39], s14 offen nt lds
    s_waitcnt vmcnt(5)
    s_add_u32 m0, s12, 31744
    s_nop 0
    buffer_load_dwordx4 v87, s[36:39], s14 offen nt lds
    s_waitcnt vmcnt(10)
    ds_read_b128 a[128:131], v88 offset:20480
    ds_read_b128 a[132:135], v89 offset:20480
    ds_read_b128 a[136:139], v90 offset:20480
    ds_read_b128 a[140:143], v91 offset:20480
    s_waitcnt lgkmcnt(4)
    s_add_u32 s14, s19, 45056
    s_and_b32 s14, s14, 65535
    s_waitcnt vmcnt(5)
    s_add_u32 m0, s12, 32768
    s_nop 0
    buffer_load_dwordx4 v84, s[36:39], s14 offen nt lds
    s_waitcnt vmcnt(5)
    s_add_u32 m0, s12, 33792
    s_nop 0
    buffer_load_dwordx4 v85, s[36:39], s14 offen nt lds
    s_waitcnt vmcnt(5)
    s_add_u32 m0, s12, 34816
    s_nop 0
    buffer_load_dwordx4 v86, s[36:39], s14 offen nt lds
    s_waitcnt vmcnt(5)
    s_add_u32 m0, s12, 35840
    s_nop 0
    buffer_load_dwordx4 v87, s[36:39], s14 offen nt lds
    s_waitcnt vmcnt(9)
    ds_read_b128 a[144:147], v88 offset:24576
    ds_read_b128 a[148:151], v89 offset:24576
    ds_read_b128 a[152:155], v90 offset:24576
    ds_read_b128 a[156:159], v91 offset:24576
    s_waitcnt lgkmcnt(4)
    s_add_u32 s14, s19, 49152
    s_and_b32 s14, s14, 65535
    s_waitcnt vmcnt(5)
    s_add_u32 m0, s12, 12288
    s_nop 0
    buffer_load_dwordx4 v84, s[36:39], s14 offen nt lds
    s_waitcnt vmcnt(5)
    s_add_u32 m0, s12, 13312
    s_nop 0
    buffer_load_dwordx4 v85, s[36:39], s14 offen nt lds
    s_waitcnt vmcnt(5)
    s_add_u32 m0, s12, 14336
    s_nop 0
    buffer_load_dwordx4 v86, s[36:39], s14 offen nt lds
    s_waitcnt vmcnt(5)
    s_add_u32 m0, s12, 15360
    s_nop 0
    buffer_load_dwordx4 v87, s[36:39], s14 offen nt lds
    s_waitcnt vmcnt(8)
    ds_read_b128 a[160:163], v88 offset:28672
    ds_read_b128 a[164:167], v89 offset:28672
    ds_read_b128 a[168:171], v90 offset:28672
    ds_read_b128 a[172:175], v91 offset:28672
    s_waitcnt lgkmcnt(4)
    s_add_u32 s14, s19, 53248
    s_and_b32 s14, s14, 65535
    s_waitcnt vmcnt(5)
    s_add_u32 m0, s12, 16384
    s_nop 0
    buffer_load_dwordx4 v84, s[36:39], s14 offen nt lds
    s_waitcnt vmcnt(5)
    s_add_u32 m0, s12, 17408
    s_nop 0
    buffer_load_dwordx4 v85, s[36:39], s14 offen nt lds
    s_waitcnt vmcnt(5)
    s_add_u32 m0, s12, 18432
    s_nop 0
    buffer_load_dwordx4 v86, s[36:39], s14 offen nt lds
    s_waitcnt vmcnt(5)
    s_add_u32 m0, s12, 19456
    s_nop 0
    buffer_load_dwordx4 v87, s[36:39], s14 offen nt lds
    s_waitcnt vmcnt(8)
    ds_read_b128 a[176:179], v88 offset:32768
    ds_read_b128 a[180:183], v89 offset:32768
    ds_read_b128 a[184:187], v90 offset:32768
    ds_read_b128 a[188:191], v91 offset:32768
    s_waitcnt lgkmcnt(4)
    s_add_u32 s14, s19, 57344
    s_and_b32 s14, s14, 65535
    s_waitcnt vmcnt(5)
    s_add_u32 m0, s12, 20480
    s_nop 0
    buffer_load_dwordx4 v84, s[36:39], s14 offen nt lds
    s_waitcnt vmcnt(5)
    s_add_u32 m0, s12, 21504
    s_nop 0
    buffer_load_dwordx4 v85, s[36:39], s14 offen nt lds
    s_waitcnt vmcnt(5)
    s_add_u32 m0, s12, 22528
    s_nop 0
    buffer_load_dwordx4 v86, s[36:39], s14 offen nt lds
    s_waitcnt vmcnt(5)
    s_add_u32 m0, s12, 23552
    s_nop 0
    buffer_load_dwordx4 v87, s[36:39], s14 offen nt lds
    s_waitcnt vmcnt(8)
    ds_read_b128 a[192:195], v88 offset:12288
    ds_read_b128 a[196:199], v89 offset:12288
    ds_read_b128 a[200:203], v90 offset:12288
    ds_read_b128 a[204:207], v91 offset:12288
    s_waitcnt lgkmcnt(4)
    s_add_u32 s14, s19, 61440
    s_and_b32 s14, s14, 65535
    s_waitcnt vmcnt(5)
    s_add_u32 m0, s12, 24576
    s_nop 0
    buffer_load_dwordx4 v84, s[36:39], s14 offen nt lds
    s_waitcnt vmcnt(5)
    s_add_u32 m0, s12, 25600
    s_nop 0
    buffer_load_dwordx4 v85, s[36:39], s14 offen nt lds
    s_waitcnt vmcnt(5)
    s_add_u32 m0, s12, 26624
    s_nop 0
    buffer_load_dwordx4 v86, s[36:39], s14 offen nt lds
    s_waitcnt vmcnt(5)
    s_add_u32 m0, s12, 27648
    s_nop 0
    buffer_load_dwordx4 v87, s[36:39], s14 offen nt lds
    s_waitcnt vmcnt(8)
    ds_read_b128 a[208:211], v88 offset:16384
    ds_read_b128 a[212:215], v89 offset:16384
    ds_read_b128 a[216:219], v90 offset:16384
    ds_read_b128 a[220:223], v91 offset:16384
    v_mov_b32 v28, 0
    v_mov_b32 v29, 0
    v_mov_b32 v30, 0
    v_mov_b32 v31, 0
    s_lshr_b32 s89, s5, 2
    s_lshl_b32 s89, s89, 8
    s_add_u32 s89, s89, s6
    s_mov_b64 exec, s[28:29]
    buffer_load_dwordx4 v[28:31], v11, s[60:63], s89 offen sc1
    s_mov_b64 exec, s[20:21]
    s_add_u32 s14, s19, 0
    s_and_b32 s86, s14, 65535
    s_add_u32 s14, s19, 4096
    s_and_b32 s88, s14, 65535
    s_waitcnt vmcnt(4)
    buffer_load_dwordx4 v[96:99], v16, s[40:43], s86 offen offset:0 nt
    s_waitcnt vmcnt(4)
    buffer_load_dwordx4 v[104:107], v16, s[40:43], s88 offen offset:0 nt
    s_waitcnt vmcnt(4)
    buffer_load_dwordx4 v[112:115], v16, s[40:43], s86 offen offset:1024 nt
    s_waitcnt vmcnt(8)
    ds_read_b128 a[224:227], v88 offset:20480
    ds_read_b128 a[228:231], v89 offset:20480
    ds_read_b128 a[232:235], v90 offset:20480
    ds_read_b128 a[236:239], v91 offset:20480
    s_waitcnt vmcnt(4)
    buffer_load_dwordx4 v[120:123], v16, s[40:43], s88 offen offset:1024 nt
    s_waitcnt vmcnt(4)
    buffer_load_dwordx4 v[128:131], v16, s[40:43], s86 offen offset:2048 nt
    s_waitcnt vmcnt(4)
    buffer_load_dwordx4 v[136:139], v16, s[40:43], s88 offen offset:2048 nt
    s_waitcnt vmcnt(7)
    ds_read_b128 a[240:243], v88 offset:24576
    ds_read_b128 a[244:247], v89 offset:24576
    ds_read_b128 a[248:251], v90 offset:24576
    ds_read_b128 a[252:255], v91 offset:24576
    v_mov_b32 v48, 0
    v_mov_b32 v49, 0
    v_mov_b32 v52, 0
    v_mov_b32 v53, 0
    v_mov_b32 v56, 0
    v_mov_b32 v57, 0
    v_mov_b32 v60, 0
    v_mov_b32 v61, 0
    v_mov_b32 v64, 0
    v_mov_b32 v65, 0
    v_mov_b32 v68, 0
    v_mov_b32 v69, 0
    v_mov_b32 v72, 0
    v_mov_b32 v73, 0
    v_mov_b32 v76, 0
    v_mov_b32 v77, 0
    v_mov_b32 v80, 0
    v_mov_b32 v81, 0
    v_mov_b32 v84, 0
    v_mov_b32 v85, 0
    v_mov_b32 v88, 0
    v_mov_b32 v89, 0
    v_mov_b32 v92, 0
    v_mov_b32 v93, 0
    s_waitcnt vmcnt(6)
    v_max_u32 v32, v28, v29
    v_max3_u32 v32, v30, v31, v32
    v_cmp_eq_u32 vcc, -1, v32
    s_cbranch_vccz L_q1ok
L_poll_3:
    s_mov_b64 exec, s[28:29]
    buffer_load_dwordx4 v[28:31], v11, s[60:63], s89 offen sc1
    s_mov_b64 exec, s[20:21]
    s_sub_u32 s11, s11, 1
    s_cbranch_scc1 L_abort
    s_waitcnt vmcnt(0)
    v_max_u32 v32, v28, v29
    v_max3_u32 v32, v30, v31, v32
    v_cmp_eq_u32 vcc, -1, v32
    s_cbranch_vccnz L_poll_3
L_q1ok:
    s_waitcnt vmcnt(4)
    buffer_load_dwordx4 v[144:147], v16, s[40:43], s86 offen offset:3072 nt
    s_waitcnt lgkmcnt(0)
    s_waitcnt vmcnt(4)
    buffer_load_dwordx4 v[152:155], v16, s[40:43], s88 offen offset:3072 nt
    v_and_b32_dpp v32, v28, v26 quad_perm:[0,1,0,0] row_mask:0xf bank_mask:0xf
    v_and_b32_dpp v33, v29, v26 quad_perm:[0,1,0,0] row_mask:0xf bank_mask:0xf
    v_and_b32_dpp v34, v30, v26 quad_perm:[0,1,0,0] row_mask:0xf bank_mask:0xf
    v_and_b32_dpp v35, v31, v26 quad_perm:[0,1,0,0] row_mask:0xf bank_mask:0xf
    s_nop 1
    v_smfmac_f32_16x16x64_bf16 v[48:51], v[32:35], a[0:7], v23
    v_and_b32_dpp v36, v28, v26 quad_perm:[2,3,0,0] row_mask:0xf bank_mask:0xf
    v_and_b32_dpp v37, v29, v26 quad_perm:[2,3,0,0] row_mask:0xf bank_mask:0xf
    v_smfmac_f32_16x16x64_bf16 v[52:55], v[32:35], a[16:23], v23
    v_and_b32_dpp v38, v30, v26 quad_perm:[2,3,0,0] row_mask:0xf bank_mask:0xf
    v_and_b32_dpp v39, v31, v26 quad_perm:[2,3,0,0] row_mask:0xf bank_mask:0xf
    v_smfmac_f32_16x16x64_bf16 v[56:59], v[32:35], a[128:135], v23
    v_smfmac_f32_16x16x64_bf16 v[60:63], v[32:35], a[144:151], v23
    s_add_u32 s14, s19, 8192
    s_and_b32 s86, s14, 65535
    s_add_u32 s14, s19, 12288
    s_and_b32 s88, s14, 65535
    s_waitcnt vmcnt(4)
    buffer_load_dwordx4 v[100:103], v16, s[40:43], s86 offen offset:0 nt
    v_smfmac_f32_16x16x64_bf16 v[48:51], v[36:39], a[8:15], v23
    v_mov_b32_dpp v40, v32 row_shr:4 row_mask:0xf bank_mask:0xf bound_ctrl:0
    v_mov_b32_dpp v41, v33 row_shr:4 row_mask:0xf bank_mask:0xf bound_ctrl:0
    v_smfmac_f32_16x16x64_bf16 v[52:55], v[36:39], a[24:31], v23
    v_mov_b32_dpp v42, v34 row_shr:4 row_mask:0xf bank_mask:0xf bound_ctrl:0
    v_mov_b32_dpp v43, v35 row_shr:4 row_mask:0xf bank_mask:0xf bound_ctrl:0
    v_smfmac_f32_16x16x64_bf16 v[56:59], v[36:39], a[136:143], v23
    v_smfmac_f32_16x16x64_bf16 v[60:63], v[36:39], a[152:159], v23
    v_smfmac_f32_16x16x64_bf16 v[48:51], v[40:43], a[32:39], v23
    v_mov_b32_dpp v44, v36 row_shr:4 row_mask:0xf bank_mask:0xf bound_ctrl:0
    v_mov_b32_dpp v45, v37 row_shr:4 row_mask:0xf bank_mask:0xf bound_ctrl:0
    v_smfmac_f32_16x16x64_bf16 v[52:55], v[40:43], a[48:55], v23
    s_waitcnt vmcnt(4)
    buffer_load_dwordx4 v[108:111], v16, s[40:43], s88 offen offset:0 nt
    v_mov_b32_dpp v46, v38 row_shr:4 row_mask:0xf bank_mask:0xf bound_ctrl:0
    v_mov_b32_dpp v47, v39 row_shr:4 row_mask:0xf bank_mask:0xf bound_ctrl:0
    v_smfmac_f32_16x16x64_bf16 v[56:59], v[40:43], a[160:167], v23
    v_smfmac_f32_16x16x64_bf16 v[60:63], v[40:43], a[176:183], v23
    v_smfmac_f32_16x16x64_bf16 v[48:51], v[44:47], a[40:47], v23
    v_mov_b32_dpp v40, v32 row_shr:8 row_mask:0xf bank_mask:0xf bound_ctrl:0
    v_mov_b32_dpp v41, v33 row_shr:8 row_mask:0xf bank_mask:0xf bound_ctrl:0
    v_smfmac_f32_16x16x64_bf16 v[52:55], v[44:47], a[56:63], v23
    v_mov_b32_dpp v42, v34 row_shr:8 row_mask:0xf bank_mask:0xf bound_ctrl:0
    v_mov_b32_dpp v43, v35 row_shr:8 row_mask:0xf bank_mask:0xf bound_ctrl:0
    v_smfmac_f32_16x16x64_bf16 v[56:59], v[44:47], a[168:175], v23
    v_smfmac_f32_16x16x64_bf16 v[60:63], v[44:47], a[184:191], v23
    v_smfmac_f32_16x16x64_bf16 v[48:51], v[40:43], a[64:71], v23
    s_waitcnt vmcnt(4)
    buffer_load_dwordx4 v[116:119], v16, s[40:43], s86 offen offset:1024 nt
    v_mov_b32_dpp v44, v36 row_shr:8 row_mask:0xf bank_mask:0xf bound_ctrl:0
    v_mov_b32_dpp v45, v37 row_shr:8 row_mask:0xf bank_mask:0xf bound_ctrl:0
    v_smfmac_f32_16x16x64_bf16 v[52:55], v[40:43], a[80:87], v23
    v_mov_b32_dpp v46, v38 row_shr:8 row_mask:0xf bank_mask:0xf bound_ctrl:0
    v_mov_b32_dpp v47, v39 row_shr:8 row_mask:0xf bank_mask:0xf bound_ctrl:0
    v_smfmac_f32_16x16x64_bf16 v[56:59], v[40:43], a[192:199], v23
    v_smfmac_f32_16x16x64_bf16 v[60:63], v[40:43], a[208:215], v23
    v_smfmac_f32_16x16x64_bf16 v[48:51], v[44:47], a[72:79], v23
    v_mov_b32_dpp v40, v32 row_shr:12 row_mask:0xf bank_mask:0xf bound_ctrl:0
    v_mov_b32_dpp v41, v33 row_shr:12 row_mask:0xf bank_mask:0xf bound_ctrl:0
    v_smfmac_f32_16x16x64_bf16 v[52:55], v[44:47], a[88:95], v23
    v_mov_b32_dpp v42, v34 row_shr:12 row_mask:0xf bank_mask:0xf bound_ctrl:0
    s_waitcnt vmcnt(4)
    buffer_load_dwordx4 v[124:127], v16, s[40:43], s88 offen offset:1024 nt
    v_mov_b32_dpp v43, v35 row_shr:12 row_mask:0xf bank_mask:0xf bound_ctrl:0
    v_smfmac_f32_16x16x64_bf16 v[56:59], v[44:47], a[200:207], v23
    v_smfmac_f32_16x16x64_bf16 v[60:63], v[44:47], a[216:223], v23
    v_smfmac_f32_16x16x64_bf16 v[48:51], v[40:43], a[96:103], v23
    v_mov_b32_dpp v44, v36 row_shr:12 row_mask:0xf bank_mask:0xf bound_ctrl:0
    v_mov_b32_dpp v45, v37 row_shr:12 row_mask:0xf bank_mask:0xf bound_ctrl:0
    v_smfmac_f32_16x16x64_bf16 v[52:55], v[40:43], a[112:119], v23
    v_mov_b32_dpp v46, v38 row_shr:12 row_mask:0xf bank_mask:0xf bound_ctrl:0
    v_mov_b32_dpp v47, v39 row_shr:12 row_mask:0xf bank_mask:0xf bound_ctrl:0
    v_smfmac_f32_16x16x64_bf16 v[56:59], v[40:43], a[224:231], v23
    v_smfmac_f32_16x16x64_bf16 v[60:63], v[40:43], a[240:247], v23
    v_smfmac_f32_16x16x64_bf16 v[48:51], v[44:47], a[104:111], v23
    v_smfmac_f32_16x16x64_bf16 v[52:55], v[44:47], a[120:127], v23
    s_waitcnt vmcnt(4)
    buffer_load_dwordx4 v[132:135], v16, s[40:43], s86 offen offset:2048 nt
    v_smfmac_f32_16x16x64_bf16 v[56:59], v[44:47], a[232:239], v23
    v_smfmac_f32_16x16x64_bf16 v[60:63], v[44:47], a[248:255], v23
    s_nop 2
    v_add_f32 v48, v48, v49
    v_add_f32 v49, v52, v53
    s_nop 1
    v_add_f32 v50, v56, v57
    v_add_f32 v51, v60, v61
    v_max_f32 v56, v48, v49
    v_max3_f32 v56, v50, v51, v56
    s_nop 1
    v_max_f32_dpp v56, v56, v56 quad_perm:[1,0,3,2] row_mask:0xf bank_mask:0xf
    s_nop 1
    v_max_f32_dpp v56, v56, v56 quad_perm:[2,3,0,1] row_mask:0xf bank_mask:0xf
    s_nop 1
    v_max_f32_dpp v56, v56, v56 row_ror:4 row_mask:0xf bank_mask:0xf
    s_nop 1
    v_max_f32_dpp v56, v56, v56 row_ror:8 row_mask:0xf bank_mask:0xf
    s_waitcnt vmcnt(4)
    buffer_load_dwordx4 v[140:143], v16, s[40:43], s88 offen offset:2048 nt
    v_mov_b32 v57, v56
    s_nop 1
    v_permlane32_swap_b32 v57, v56
    v_max_f32 v56, v56, v57
    v_mov_b32 v57, v56
    s_nop 1
    v_permlane16_swap_b32 v57, v56
    v_max_f32 v56, v56, v57
    v_mul_f32 v56, s78, v56
    v_fma_f32 v48, v48, s78, -v56
    v_fma_f32 v49, v49, s78, -v56
    v_fma_f32 v50, v50, s78, -v56
    v_fma_f32 v51, v51, s78, -v56
    v_exp_f32 v48, v48
    v_exp_f32 v49, v49
    s_waitcnt vmcnt(4)
    buffer_load_dwordx4 v[148:151], v16, s[40:43], s86 offen offset:3072 nt
    v_exp_f32 v50, v50
    v_exp_f32 v51, v51
    v_cvt_pk_bf16_f32 v52, v48, v49
    v_cvt_pk_bf16_f32 v53, v50, v51
    ds_write2_b32 v24, v52, v53 offset0:0 offset1:64
    s_mov_b64 exec, s[32:33]
    ds_write_b32 v17, v56 offset:2048
    s_mov_b64 exec, s[20:21]
    v_pk_add_f32 v[48:49], v[48:49], v[50:51]
    v_add_f32 v57, v48, v49
    v_mov_b32 v62, 0
    s_waitcnt lgkmcnt(0)
    ds_read_b128 v[28:31], v25 offset:0
    ds_read_b128 v[32:35], v25 offset:128
    s_waitcnt vmcnt(4)
    buffer_load_dwordx4 v[156:159], v16, s[40:43], s88 offen offset:3072 nt
    ds_read_b128 v[36:39], v25 offset:256
    ds_read_b128 v[40:43], v25 offset:384
    v_add_f32_dpp v57, v57, v57 quad_perm:[1,0,3,2] row_mask:0xf bank_mask:0xf
    s_nop 1
    v_add_f32_dpp v57, v57, v57 quad_perm:[2,3,0,1] row_mask:0xf bank_mask:0xf
    s_nop 1
    v_add_f32_dpp v57, v57, v57 row_ror:4 row_mask:0xf bank_mask:0xf
    s_nop 1
    v_add_f32_dpp v57, v57, v57 row_ror:8 row_mask:0xf bank_mask:0xf
    v_mov_b32 v63, v57
    s_nop 1
    v_permlane32_swap_b32 v63, v57
    v_add_f32 v57, v57, v63
    v_mov_b32 v63, v57
    s_nop 1
    v_permlane16_swap_b32 v63, v57
    v_add_f32 v57, v57, v63
    s_mov_b64 exec, s[32:33]
    ds_write_b32 v17, v57 offset:2064
    s_mov_b64 exec, s[20:21]
    s_add_u32 s14, s19, 16384
    s_and_b32 s86, s14, 65535
    s_add_u32 s14, s19, 20480
    s_and_b32 s88, s14, 65535
    s_waitcnt vmcnt(6)
    s_cmp_lg_u32 s8, 0
    s_cbranch_scc1 L_thr_4
    s_waitcnt vmcnt(4)
L_thr_4:
    buffer_load_dwordx4 v[160:163], v16, s[40:43], s86 offen offset:0 nt
    s_waitcnt vmcnt(9)
    v_perm_b32 v54, v104, v96, s16
    v_perm_b32 v104, v104, v96, s17
    v_mov_b32 v96, v54
    v_perm_b32 v54, v121, v113, s16
    v_perm_b32 v121, v121, v113, s17
    v_mov_b32 v113, v54
    s_waitcnt vmcnt(6)
    s_cmp_lg_u32 s8, 0
    s_cbranch_scc1 L_thr_5
    s_waitcnt vmcnt(4)
L_thr_5:
    buffer_load_dwordx4 v[168:171], v16, s[40:43], s88 offen offset:0 nt
    v_perm_b32 v54, v138, v130, s16
    v_perm_b32 v138, v138, v130, s17
    v_mov_b32 v130, v54
    v_perm_b32 v54, v155, v147, s16
    v_perm_b32 v155, v155, v147, s17
    v_mov_b32 v147, v54
    v_perm_b32 v54, v105, v97, s16
    v_perm_b32 v55, v105, v97, s17
    s_waitcnt vmcnt(6)
    s_cmp_lg_u32 s8, 0
    s_cbranch_scc1 L_thr_6
    s_waitcnt vmcnt(4)
L_thr_6:
    buffer_load_dwordx4 v[176:179], v16, s[40:43], s86 offen offset:1024 nt
    v_perm_b32 v97, v120, v112, s16
    v_perm_b32 v105, v120, v112, s17
    v_mov_b32 v112, v54
    v_mov_b32 v120, v55
    v_perm_b32 v54, v106, v98, s16
    v_perm_b32 v55, v106, v98, s17
    v_perm_b32 v98, v136, v128, s16
    v_perm_b32 v106, v136, v128, s17
    s_waitcnt vmcnt(6)
    s_cmp_lg_u32 s8, 0
    s_cbranch_scc1 L_thr_7
    s_waitcnt vmcnt(4)
L_thr_7:
    buffer_load_dwordx4 v[184:187], v16, s[40:43], s88 offen offset:1024 nt
    v_mov_b32 v128, v54
    v_mov_b32 v136, v55
    v_perm_b32 v54, v107, v99, s16
    v_perm_b32 v55, v107, v99, s17
    v_perm_b32 v99, v152, v144, s16
    v_perm_b32 v107, v152, v144, s17
    v_mov_b32 v144, v54
    v_mov_b32 v152, v55
    s_waitcnt vmcnt(6)
    s_cmp_lg_u32 s8, 0
    s_cbranch_scc1 L_thr_8
    s_waitcnt vmcnt(4)
L_thr_8:
    buffer_load_dwordx4 v[192:195], v16, s[40:43], s86 offen offset:2048 nt
    v_perm_b32 v54, v122, v114, s16
    v_perm_b32 v55, v122, v114, s17
    v_perm_b32 v114, v137, v129, s16
    v_perm_b32 v122, v137, v129, s17
    v_mov_b32 v129, v54
    v_mov_b32 v137, v55
    v_perm_b32 v54, v123, v115, s16
    s_waitcnt vmcnt(6)
    s_cmp_lg_u32 s8, 0
    s_cbranch_scc1 L_thr_9
    s_waitcnt vmcnt(4)
L_thr_9:
    buffer_load_dwordx4 v[200:203], v16, s[40:43], s88 offen offset:2048 nt
    v_perm_b32 v55, v123, v115, s17
    v_perm_b32 v115, v153, v145, s16
    v_perm_b32 v123, v153, v145, s17
    v_mov_b32 v145, v54
    v_mov_b32 v153, v55
    v_perm_b32 v54, v139, v131, s16
    v_perm_b32 v55, v139, v131, s17
    v_perm_b32 v131, v154, v146, s16
    s_waitcnt vmcnt(6)
    s_cmp_lg_u32 s8, 0
    s_cbranch_scc1 L_thr_10
    s_waitcnt vmcnt(4)
L_thr_10:
    buffer_load_dwordx4 v[208:211], v16, s[40:43], s86 offen offset:3072 nt
    v_perm_b32 v139, v154, v146, s17
    v_mov_b32 v146, v54
    v_mov_b32 v154, v55
    s_waitcnt vmcnt(7)
    v_perm_b32 v54, v108, v100, s16
    v_perm_b32 v108, v108, v100, s17
    v_mov_b32 v100, v54
    v_perm_b32 v54, v125, v117, s16
    s_waitcnt vmcnt(6)
    s_cmp_lg_u32 s8, 0
    s_cbranch_scc1 L_thr_11
    s_waitcnt vmcnt(4)
L_thr_11:
    buffer_load_dwordx4 v[216:219], v16, s[40:43], s88 offen offset:3072 nt
    v_perm_b32 v125, v125, v117, s17
    v_mov_b32 v117, v54
    v_perm_b32 v54, v142, v134, s16
    v_perm_b32 v142, v142, v134, s17
    v_mov_b32 v134, v54
    v_perm_b32 v54, v159, v151, s16
    v_perm_b32 v159, v159, v151, s17
    v_mov_b32 v151, v54
    s_add_u32 s14, s19, 24576
    s_and_b32 s86, s14, 65535
    s_add_u32 s14, s19, 28672
    s_and_b32 s88, s14, 65535
    s_waitcnt vmcnt(6)
    s_cmp_lg_u32 s8, 0
    s_cbranch_scc1 L_thr_12
    s_waitcnt vmcnt(4)
L_thr_12:
    buffer_load_dwordx4 v[164:167], v16, s[40:43], s86 offen offset:0 nt
    v_perm_b32 v54, v109, v101, s16
    v_perm_b32 v55, v109, v101, s17
    v_perm_b32 v101, v124, v116, s16
    v_perm_b32 v109, v124, v116, s17
    v_mov_b32 v116, v54
    v_mov_b32 v124, v55
    v_perm_b32 v54, v110, v102, s16
    s_waitcnt vmcnt(6)
    s_cmp_lg_u32 s8, 0
    s_cbranch_scc1 L_thr_13
    s_waitcnt vmcnt(4)
L_thr_13:
    buffer_load_dwordx4 v[172:175], v16, s[40:43], s88 offen offset:0 nt
    v_perm_b32 v55, v110, v102, s17
    v_perm_b32 v102, v140, v132, s16
    v_perm_b32 v110, v140, v132, s17
    v_mov_b32 v132, v54
    v_mov_b32 v140, v55
    v_perm_b32 v54, v111, v103, s16
    v_perm_b32 v55, v111, v103, s17
    v_perm_b32 v103, v156, v148, s16
    s_waitcnt vmcnt(6)
    s_cmp_lg_u32 s8, 0
    s_cbranch_scc1 L_thr_14
    s_waitcnt vmcnt(4)
L_thr_14:
    buffer_load_dwordx4 v[180:183], v16, s[40:43], s86 offen offset:1024 nt
    v_perm_b32 v111, v156, v148, s17
    v_mov_b32 v148, v54
    v_mov_b32 v156, v55
    v_perm_b32 v54, v126, v118, s16
    v_perm_b32 v55, v126, v118, s17
    v_perm_b32 v118, v141, v133, s16
    v_perm_b32 v126, v141, v133, s17
    v_mov_b32 v133, v54
    s_waitcnt vmcnt(6)
    s_cmp_lg_u32 s8, 0
    s_cbranch_scc1 L_thr_15
    s_waitcnt vmcnt(4)
L_thr_15:
    buffer_load_dwordx4 v[188:191], v16, s[40:43], s88 offen offset:1024 nt
    v_mov_b32 v141, v55
    v_perm_b32 v54, v127, v119, s16
    v_perm_b32 v55, v127, v119, s17
    v_perm_b32 v119, v157, v149, s16
    v_perm_b32 v127, v157, v149, s17
    v_mov_b32 v149, v54
    v_mov_b32 v157, v55
    v_perm_b32 v54, v143, v135, s16
    s_waitcnt vmcnt(6)
    s_cmp_lg_u32 s8, 0
    s_cbranch_scc1 L_thr_16
    s_waitcnt vmcnt(4)
L_thr_16:
    buffer_load_dwordx4 v[196:199], v16, s[40:43], s86 offen offset:2048 nt
    v_perm_b32 v55, v143, v135, s17
    v_perm_b32 v135, v158, v150, s16
    v_perm_b32 v143, v158, v150, s17
    v_mov_b32 v150, v54
    v_mov_b32 v158, v55
    s_waitcnt lgkmcnt(0)
    v_smfmac_f32_16x16x64_bf16 v[64:67], v[28:31], v[96:103], v23
    s_waitcnt vmcnt(6)
    s_cmp_lg_u32 s8, 0
    s_cbranch_scc1 L_thr_17
    s_waitcnt vmcnt(4)
L_thr_17:
    buffer_load_dwordx4 v[204:207], v16, s[40:43], s88 offen offset:2048 nt
    v_smfmac_f32_16x16x64_bf16 v[68:71], v[28:31], v[104:111], v23
    v_smfmac_f32_16x16x64_bf16 v[72:75], v[28:31], v[112:119], v23
    v_smfmac_f32_16x16x64_bf16 v[76:79], v[28:31], v[120:127], v23
    v_smfmac_f32_16x16x64_bf16 v[80:83], v[28:31], v[128:135], v23
    v_smfmac_f32_16x16x64_bf16 v[84:87], v[28:31], v[136:143], v23
    v_smfmac_f32_16x16x64_bf16 v[88:91], v[28:31], v[144:151], v23
    v_smfmac_f32_16x16x64_bf16 v[92:95], v[28:31], v[152:159], v23
    ds_write_b128 v22, v[96:99] offset:12288
    s_waitcnt vmcnt(6)
    s_cmp_lg_u32 s8, 0
    s_cbranch_scc1 L_thr_18
    s_waitcnt vmcnt(4)
L_thr_18:
    buffer_load_dwordx4 v[212:215], v16, s[40:43], s86 offen offset:3072 nt
    ds_write_b128 v22, v[100:103] offset:13312
    ds_write_b128 v22, v[104:107] offset:14336
    ds_write_b128 v22, v[108:111] offset:15360
    ds_write_b128 v22, v[112:115] offset:16384
    ds_write_b128 v22, v[116:119] offset:17408
    ds_write_b128 v22, v[120:123] offset:18432
    ds_write_b128 v22, v[124:127] offset:19456
    ds_write_b128 v22, v[128:131] offset:20480
    s_waitcnt vmcnt(6)
    s_cmp_lg_u32 s8, 0
    s_cbranch_scc1 L_thr_19
    s_waitcnt vmcnt(4)
L_thr_19:
    buffer_load_dwordx4 v[220:223], v16, s[40:43], s88 offen offset:3072 nt
    ds_write_b128 v22, v[132:135] offset:21504
    ds_write_b128 v22, v[136:139] offset:22528
    ds_write_b128 v22, v[140:143] offset:23552
    ds_write_b128 v22, v[144:147] offset:24576
    ds_write_b128 v22, v[148:151] offset:25600
    ds_write_b128 v22, v[152:155] offset:26624
    ds_write_b128 v22, v[156:159] offset:27648
    s_waitcnt lgkmcnt(0)
    s_add_u32 s14, s19, 32768
    s_and_b32 s86, s14, 65535
    s_add_u32 s14, s19, 36864
    s_and_b32 s88, s14, 65535
    s_waitcnt vmcnt(6)
    s_cmp_lg_u32 s8, 0
    s_cbranch_scc1 L_thr_20
    s_waitcnt vmcnt(4)
L_thr_20:
    buffer_load_dwordx4 v[96:99], v16, s[40:43], s86 offen offset:0 nt
    s_waitcnt vmcnt(9)
    v_perm_b32 v54, v168, v160, s16
    v_perm_b32 v168, v168, v160, s17
    v_mov_b32 v160, v54
    v_perm_b32 v54, v185, v177, s16
    v_perm_b32 v185, v185, v177, s17
    v_mov_b32 v177, v54
    v_perm_b32 v54, v202, v194, s16
    v_perm_b32 v202, v202, v194, s17
    s_waitcnt vmcnt(6)
    s_cmp_lg_u32 s8, 0
    s_cbranch_scc1 L_thr_21
    s_waitcnt vmcnt(4)
L_thr_21:
    buffer_load_dwordx4 v[104:107], v16, s[40:43], s88 offen offset:0 nt
    v_mov_b32 v194, v54
    v_perm_b32 v54, v219, v211, s16
    v_perm_b32 v219, v219, v211, s17
    v_mov_b32 v211, v54
    v_perm_b32 v54, v169, v161, s16
    v_perm_b32 v55, v169, v161, s17
    v_perm_b32 v161, v184, v176, s16
    v_perm_b32 v169, v184, v176, s17
    v_mov_b32 v176, v54
    s_waitcnt vmcnt(6)
    s_cmp_lg_u32 s8, 0
    s_cbranch_scc1 L_thr_22
    s_waitcnt vmcnt(4)
L_thr_22:
    buffer_load_dwordx4 v[112:115], v16, s[40:43], s86 offen offset:1024 nt
    v_mov_b32 v184, v55
    v_perm_b32 v54, v170, v162, s16
    v_perm_b32 v55, v170, v162, s17
    v_perm_b32 v162, v200, v192, s16
    v_perm_b32 v170, v200, v192, s17
    v_mov_b32 v192, v54
    v_mov_b32 v200, v55
    v_perm_b32 v54, v171, v163, s16
    v_perm_b32 v55, v171, v163, s17
    s_waitcnt vmcnt(6)
    s_cmp_lg_u32 s8, 0
    s_cbranch_scc1 L_thr_23
    s_waitcnt vmcnt(4)
L_thr_23:
    buffer_load_dwordx4 v[120:123], v16, s[40:43], s88 offen offset:1024 nt
    v_perm_b32 v163, v216, v208, s16
    v_perm_b32 v171, v216, v208, s17
    v_mov_b32 v208, v54
    v_mov_b32 v216, v55
    v_perm_b32 v54, v186, v178, s16
    v_perm_b32 v55, v186, v178, s17
    v_perm_b32 v178, v201, v193, s16
    v_perm_b32 v186, v201, v193, s17
    v_mov_b32 v193, v54
    s_waitcnt vmcnt(6)
    s_cmp_lg_u32 s8, 0
    s_cbranch_scc1 L_thr_24
    s_waitcnt vmcnt(4)
L_thr_24:
    buffer_load_dwordx4 v[128:131], v16, s[40:43], s86 offen offset:2048 nt
    v_mov_b32 v201, v55
    v_perm_b32 v54, v187, v179, s16
    v_perm_b32 v55, v187, v179, s17
    v_perm_b32 v179, v217, v209, s16
    v_perm_b32 v187, v217, v209, s17
    v_mov_b32 v209, v54
    v_mov_b32 v217, v55
    v_perm_b32 v54, v203, v195, s16
    v_perm_b32 v55, v203, v195, s17
    s_waitcnt vmcnt(6)
    s_cmp_lg_u32 s8, 0
    s_cbranch_scc1 L_thr_25
    s_waitcnt vmcnt(4)
L_thr_25:
    buffer_load_dwordx4 v[136:139], v16, s[40:43], s88 offen offset:2048 nt
    v_perm_b32 v195, v218, v210, s16
    v_perm_b32 v203, v218, v210, s17
    v_mov_b32 v210, v54
    v_mov_b32 v218, v55
    s_waitcnt vmcnt(6)
    v_perm_b32 v54, v172, v164, s16
    v_perm_b32 v172, v172, v164, s17
    v_mov_b32 v164, v54
    v_perm_b32 v54, v189, v181, s16
    v_perm_b32 v189, v189, v181, s17
    s_waitcnt vmcnt(6)
    s_cmp_lg_u32 s8, 0
    s_cbranch_scc1 L_thr_26
    s_waitcnt vmcnt(4)
L_thr_26:
    buffer_load_dwordx4 v[144:147], v16, s[40:43], s86 offen offset:3072 nt
    v_mov_b32 v181, v54
    v_perm_b32 v54, v206, v198, s16
    v_perm_b32 v206, v206, v198, s17
    v_mov_b32 v198, v54
    v_perm_b32 v54, v223, v215, s16
    v_perm_b32 v223, v223, v215, s17
    v_mov_b32 v215, v54
    v_perm_b32 v54, v173, v165, s16
    v_perm_b32 v55, v173, v165, s17
    s_waitcnt vmcnt(6)
    s_cmp_lg_u32 s8, 0
    s_cbranch_scc1 L_thr_27
    s_waitcnt vmcnt(4)
L_thr_27:
    buffer_load_dwordx4 v[152:155], v16, s[40:43], s88 offen offset:3072 nt
    v_perm_b32 v165, v188, v180, s16
    v_perm_b32 v173, v188, v180, s17
    v_mov_b32 v180, v54
    v_mov_b32 v188, v55
    v_perm_b32 v54, v174, v166, s16
    v_perm_b32 v55, v174, v166, s17
    v_perm_b32 v166, v204, v196, s16
    v_perm_b32 v174, v204, v196, s17
    v_mov_b32 v196, v54
    s_add_u32 s14, s19, 40960
    s_and_b32 s86, s14, 65535
    s_add_u32 s14, s19, 45056
    s_and_b32 s88, s14, 65535
    s_waitcnt vmcnt(6)
    s_cmp_lg_u32 s8, 0
    s_cbranch_scc1 L_thr_28
    s_waitcnt vmcnt(4)
L_thr_28:
    buffer_load_dwordx4 v[100:103], v16, s[40:43], s86 offen offset:0 nt
    v_mov_b32 v204, v55
    v_perm_b32 v54, v175, v167, s16
    v_perm_b32 v55, v175, v167, s17
    v_perm_b32 v167, v220, v212, s16
    v_perm_b32 v175, v220, v212, s17
    v_mov_b32 v212, v54
    v_mov_b32 v220, v55
    v_perm_b32 v54, v190, v182, s16
    v_perm_b32 v55, v190, v182, s17
    s_waitcnt vmcnt(6)
    s_cmp_lg_u32 s8, 0
    s_cbranch_scc1 L_thr_29
    s_waitcnt vmcnt(4)
L_thr_29:
    buffer_load_dwordx4 v[108:111], v16, s[40:43], s88 offen offset:0 nt
    v_perm_b32 v182, v205, v197, s16
    v_perm_b32 v190, v205, v197, s17
    v_mov_b32 v197, v54
    v_mov_b32 v205, v55
    v_perm_b32 v54, v191, v183, s16
    v_perm_b32 v55, v191, v183, s17
    v_perm_b32 v183, v221, v213, s16
    v_perm_b32 v191, v221, v213, s17
    v_mov_b32 v213, v54
    s_waitcnt vmcnt(6)
    s_cmp_lg_u32 s8, 0
    s_cbranch_scc1 L_thr_30
    s_waitcnt vmcnt(4)
L_thr_30:
    buffer_load_dwordx4 v[116:119], v16, s[40:43], s86 offen offset:1024 nt
    v_mov_b32 v221, v55
    v_perm_b32 v54, v207, v199, s16
    v_perm_b32 v55, v207, v199, s17
    v_perm_b32 v199, v222, v214, s16
    v_perm_b32 v207, v222, v214, s17
    v_mov_b32 v214, v54
    v_mov_b32 v222, v55
    v_smfmac_f32_16x16x64_bf16 v[64:67], v[32:35], v[160:167], v23
    v_smfmac_f32_16x16x64_bf16 v[68:71], v[32:35], v[168:175], v23
    v_smfmac_f32_16x16x64_bf16 v[72:75], v[32:35], v[176:183], v23
    s_waitcnt vmcnt(6)
    s_cmp_lg_u32 s8, 0
    s_cbranch_scc1 L_thr_31
    s_waitcnt vmcnt(4)
L_thr_31:
    buffer_load_dwordx4 v[124:127], v16, s[40:43], s88 offen offset:1024 nt
    v_smfmac_f32_16x16x64_bf16 v[76:79], v[32:35], v[184:191], v23
    v_smfmac_f32_16x16x64_bf16 v[80:83], v[32:35], v[192:199], v23
    v_smfmac_f32_16x16x64_bf16 v[84:87], v[32:35], v[200:207], v23
    v_smfmac_f32_16x16x64_bf16 v[88:91], v[32:35], v[208:215], v23
    v_smfmac_f32_16x16x64_bf16 v[92:95], v[32:35], v[216:223], v23
    ds_write_b128 v22, v[160:163] offset:28672
    ds_write_b128 v22, v[164:167] offset:29696
    ds_write_b128 v22, v[168:171] offset:30720
    ds_write_b128 v22, v[172:175] offset:31744
    s_waitcnt vmcnt(6)
    s_cmp_lg_u32 s8, 0
    s_cbranch_scc1 L_thr_32
    s_waitcnt vmcnt(4)
L_thr_32:
    buffer_load_dwordx4 v[132:135], v16, s[40:43], s86 offen offset:2048 nt
    ds_write_b128 v22, v[176:179] offset:32768
    ds_write_b128 v22, v[180:183] offset:33792
    ds_write_b128 v22, v[184:187] offset:34816
    ds_write_b128 v22, v[188:191] offset:35840
    v_mov_b32 v224, v192
    v_mov_b32 v225, v193
    v_mov_b32 v226, v194
    v_mov_b32 v227, v195
    v_mov_b32 v228, v196
    s_waitcnt vmcnt(6)
    s_cmp_lg_u32 s8, 0
    s_cbranch_scc1 L_thr_33
    s_waitcnt vmcnt(4)
L_thr_33:
    buffer_load_dwordx4 v[140:143], v16, s[40:43], s88 offen offset:2048 nt
    v_mov_b32 v229, v197
    v_mov_b32 v230, v198
    v_mov_b32 v231, v199
    v_mov_b32 v232, v200
    v_mov_b32 v233, v201
    v_mov_b32 v234, v202
    v_mov_b32 v235, v203
    v_mov_b32 v236, v204
    v_mov_b32 v237, v205
    s_waitcnt vmcnt(6)
    s_cmp_lg_u32 s8, 0
    s_cbranch_scc1 L_thr_34
    s_waitcnt vmcnt(4)
L_thr_34:
    buffer_load_dwordx4 v[148:151], v16, s[40:43], s86 offen offset:3072 nt
    v_mov_b32 v238, v206
    v_mov_b32 v239, v207
    v_mov_b32 v240, v208
    v_mov_b32 v241, v209
    v_mov_b32 v242, v210
    v_mov_b32 v243, v211
    v_mov_b32 v244, v212
    v_mov_b32 v245, v213
    v_mov_b32 v246, v214
    s_waitcnt vmcnt(6)
    s_cmp_lg_u32 s8, 0
    s_cbranch_scc1 L_thr_35
    s_waitcnt vmcnt(4)
L_thr_35:
    buffer_load_dwordx4 v[156:159], v16, s[40:43], s88 offen offset:3072 nt
    v_mov_b32 v247, v215
    v_mov_b32 v248, v216
    v_mov_b32 v249, v217
    v_mov_b32 v250, v218
    v_mov_b32 v251, v219
    v_mov_b32 v252, v220
    v_mov_b32 v253, v221
    v_mov_b32 v254, v222
    v_mov_b32 v255, v223
    s_waitcnt lgkmcnt(0)
    s_add_u32 s14, s19, 49152
    s_and_b32 s86, s14, 65535
    s_add_u32 s14, s19, 53248
    s_and_b32 s88, s14, 65535
    s_waitcnt vmcnt(4)
    buffer_load_dwordx4 v[160:163], v16, s[40:43], s86 offen offset:0 nt
    s_waitcnt vmcnt(9)
    v_perm_b32 v54, v104, v96, s16
    v_perm_b32 v104, v104, v96, s17
    v_mov_b32 v96, v54
    v_perm_b32 v54, v121, v113, s16
    v_perm_b32 v121, v121, v113, s17
    s_waitcnt vmcnt(4)
    buffer_load_dwordx4 v[168:171], v16, s[40:43], s88 offen offset:0 nt
    v_mov_b32 v113, v54
    v_perm_b32 v54, v138, v130, s16
    v_perm_b32 v138, v138, v130, s17
    v_mov_b32 v130, v54
    v_perm_b32 v54, v155, v147, s16
    v_perm_b32 v155, v155, v147, s17
    v_mov_b32 v147, v54
    s_waitcnt vmcnt(4)
    buffer_load_dwordx4 v[176:179], v16, s[40:43], s86 offen offset:1024 nt
    v_perm_b32 v54, v105, v97, s16
    v_perm_b32 v55, v105, v97, s17
    v_perm_b32 v97, v120, v112, s16
    v_perm_b32 v105, v120, v112, s17
    v_mov_b32 v112, v54
    v_mov_b32 v120, v55
    s_waitcnt vmcnt(4)
    buffer_load_dwordx4 v[184:187], v16, s[40:43], s88 offen offset:1024 nt
    v_perm_b32 v54, v106, v98, s16
    v_perm_b32 v55, v106, v98, s17
    v_perm_b32 v98, v136, v128, s16
    v_perm_b32 v106, v136, v128, s17
    v_mov_b32 v128, v54
    v_mov_b32 v136, v55
    v_perm_b32 v54, v107, v99, s16
    s_waitcnt vmcnt(4)
    buffer_load_dwordx4 v[192:195], v16, s[40:43], s86 offen offset:2048 nt
    v_perm_b32 v55, v107, v99, s17
    v_perm_b32 v99, v152, v144, s16
    v_perm_b32 v107, v152, v144, s17
    v_mov_b32 v144, v54
    v_mov_b32 v152, v55
    v_perm_b32 v54, v122, v114, s16
    v_perm_b32 v55, v122, v114, s17
    s_waitcnt vmcnt(4)
    buffer_load_dwordx4 v[200:203], v16, s[40:43], s88 offen offset:2048 nt
    v_perm_b32 v114, v137, v129, s16
    v_perm_b32 v122, v137, v129, s17
    v_mov_b32 v129, v54
    v_mov_b32 v137, v55
    v_perm_b32 v54, v123, v115, s16
    v_perm_b32 v55, v123, v115, s17
    s_waitcnt vmcnt(4)
    buffer_load_dwordx4 v[208:211], v16, s[40:43], s86 offen offset:3072 nt
    v_perm_b32 v115, v153, v145, s16
    v_perm_b32 v123, v153, v145, s17
    v_mov_b32 v145, v54
    v_mov_b32 v153, v55
    v_perm_b32 v54, v139, v131, s16
    v_perm_b32 v55, v139, v131, s17
    v_perm_b32 v131, v154, v146, s16
    s_waitcnt vmcnt(4)
    buffer_load_dwordx4 v[216:219], v16, s[40:43], s88 offen offset:3072 nt
    v_perm_b32 v139, v154, v146, s17
    v_mov_b32 v146, v54
    v_mov_b32 v154, v55
    s_waitcnt vmcnt(8)
    v_perm_b32 v54, v108, v100, s16
    v_perm_b32 v108, v108, v100, s17
    v_mov_b32 v100, v54
    s_add_u32 s14, s19, 57344
    s_and_b32 s86, s14, 65535
    s_add_u32 s14, s19, 61440
    s_and_b32 s88, s14, 65535
    s_waitcnt vmcnt(4)
    buffer_load_dwordx4 v[164:167], v16, s[40:43], s86 offen offset:0 nt
    v_perm_b32 v54, v125, v117, s16
    v_perm_b32 v125, v125, v117, s17
    v_mov_b32 v117, v54
    v_perm_b32 v54, v142, v134, s16
    v_perm_b32 v142, v142, v134, s17
    v_mov_b32 v134, v54
    s_waitcnt vmcnt(4)
    buffer_load_dwordx4 v[172:175], v16, s[40:43], s88 offen offset:0 nt
    v_perm_b32 v54, v159, v151, s16
    v_perm_b32 v159, v159, v151, s17
    v_mov_b32 v151, v54
    v_perm_b32 v54, v109, v101, s16
    v_perm_b32 v55, v109, v101, s17
    v_perm_b32 v101, v124, v116, s16
    v_perm_b32 v109, v124, v116, s17
    s_waitcnt vmcnt(4)
    buffer_load_dwordx4 v[180:183], v16, s[40:43], s86 offen offset:1024 nt
    v_mov_b32 v116, v54
    v_mov_b32 v124, v55
    v_perm_b32 v54, v110, v102, s16
    v_perm_b32 v55, v110, v102, s17
    v_perm_b32 v102, v140, v132, s16
    v_perm_b32 v110, v140, v132, s17
    s_waitcnt vmcnt(4)
    buffer_load_dwordx4 v[188:191], v16, s[40:43], s88 offen offset:1024 nt
    v_mov_b32 v132, v54
    v_mov_b32 v140, v55
    v_perm_b32 v54, v111, v103, s16
    v_perm_b32 v55, v111, v103, s17
    v_perm_b32 v103, v156, v148, s16
    v_perm_b32 v111, v156, v148, s17
    v_mov_b32 v148, v54
    s_waitcnt vmcnt(4)
    buffer_load_dwordx4 v[196:199], v16, s[40:43], s86 offen offset:2048 nt
    v_mov_b32 v156, v55
    v_perm_b32 v54, v126, v118, s16
    v_perm_b32 v55, v126, v118, s17
    v_perm_b32 v118, v141, v133, s16
    v_perm_b32 v126, v141, v133, s17
    v_mov_b32 v133, v54
    v_mov_b32 v141, v55
    s_waitcnt vmcnt(4)
    buffer_load_dwordx4 v[204:207], v16, s[40:43], s88 offen offset:2048 nt
    v_perm_b32 v54, v127, v119, s16
    v_perm_b32 v55, v127, v119, s17
    v_perm_b32 v119, v157, v149, s16
    v_perm_b32 v127, v157, v149, s17
    v_mov_b32 v149, v54
    v_mov_b32 v157, v55
    s_waitcnt vmcnt(4)
    buffer_load_dwordx4 v[212:215], v16, s[40:43], s86 offen offset:3072 nt
    v_perm_b32 v54, v143, v135, s16
    v_perm_b32 v55, v143, v135, s17
    v_perm_b32 v135, v158, v150, s16
    v_perm_b32 v143, v158, v150, s17
    v_mov_b32 v150, v54
    v_mov_b32 v158, v55
    v_smfmac_f32_16x16x64_bf16 v[64:67], v[36:39], v[96:103], v23
    s_waitcnt vmcnt(4)
    buffer_load_dwordx4 v[220:223], v16, s[40:43], s88 offen offset:3072 nt
    v_smfmac_f32_16x16x64_bf16 v[68:71], v[36:39], v[104:111], v23
    v_smfmac_f32_16x16x64_bf16 v[72:75], v[36:39], v[112:119], v23
    v_smfmac_f32_16x16x64_bf16 v[76:79], v[36:39], v[120:127], v23
    v_smfmac_f32_16x16x64_bf16 v[80:83], v[36:39], v[128:135], v23
    v_smfmac_f32_16x16x64_bf16 v[84:87], v[36:39], v[136:143], v23
    v_smfmac_f32_16x16x64_bf16 v[88:91], v[36:39], v[144:151], v23
    v_smfmac_f32_16x16x64_bf16 v[92:95], v[36:39], v[152:159], v23
    v_lshrrev_b32 v52, 2, v0
    v_and_b32 v53, 3, v0
    v_lshlrev_b32 v53, 7, v53
    v_min_u32 v53, 348, v53
    s_movk_i32 s15, 2752
    v_mad_u32_u24 v52, v52, s15, v53
    s_lshl_b32 s13, s5, 2
    s_add_u32 s13, s13, s3
    s_mul_i32 s14, s13, 11008
    s_lshl_b32 s15, s87, 5
    s_add_u32 s14, s14, s15
    s_mov_b64 exec, s[76:77]
    buffer_load_dword v27, v52, s[52:55], s14 offen
    s_mul_i32 s14, s13, 1536
    s_lshl_b32 s15, s87, 14
    s_add_u32 s14, s14, s15
    v_lshlrev_b32 v52, 7, v0
    s_mov_b64 exec, 0xfff
    buffer_load_dword v27, v52, s[56:59], s14 offen
    s_mul_i32 s14, s13, 384
    s_add_u32 s14, s14, s6
    s_mov_b64 exec, 7
    buffer_load_dword v27, v52, s[60:63], s14 offen sc1
    s_mov_b64 exec, s[20:21]
    s_waitcnt lgkmcnt(0)
    s_barrier
    ds_read_b128 v[58:61], v62 offset:2048
    s_waitcnt vmcnt(11)
    v_perm_b32 v54, v168, v160, s16
    v_perm_b32 v168, v168, v160, s17
    v_mov_b32 v160, v54
    v_perm_b32 v54, v185, v177, s16
    v_perm_b32 v185, v185, v177, s17
    v_mov_b32 v177, v54
    v_perm_b32 v54, v202, v194, s16
    v_perm_b32 v202, v202, v194, s17
    v_mov_b32 v194, v54
    v_perm_b32 v54, v219, v211, s16
    v_perm_b32 v219, v219, v211, s17
    v_mov_b32 v211, v54
    v_perm_b32 v54, v169, v161, s16
    v_perm_b32 v55, v169, v161, s17
    v_perm_b32 v161, v184, v176, s16
    v_perm_b32 v169, v184, v176, s17
    v_mov_b32 v176, v54
    v_mov_b32 v184, v55
    v_perm_b32 v54, v170, v162, s16
    v_perm_b32 v55, v170, v162, s17
    v_perm_b32 v162, v200, v192, s16
    v_perm_b32 v170, v200, v192, s17
    v_mov_b32 v192, v54
    v_mov_b32 v200, v55
    v_perm_b32 v54, v171, v163, s16
    v_perm_b32 v55, v171, v163, s17
    v_perm_b32 v163, v216, v208, s16
    v_perm_b32 v171, v216, v208, s17
    v_mov_b32 v208, v54
    v_mov_b32 v216, v55
    v_perm_b32 v54, v186, v178, s16
    v_perm_b32 v55, v186, v178, s17
    v_perm_b32 v178, v201, v193, s16
    v_perm_b32 v186, v201, v193, s17
    v_mov_b32 v193, v54
    v_mov_b32 v201, v55
    v_perm_b32 v54, v187, v179, s16
    v_perm_b32 v55, v187, v179, s17
    v_perm_b32 v179, v217, v209, s16
    v_perm_b32 v187, v217, v209, s17
    v_mov_b32 v209, v54
    v_mov_b32 v217, v55
    v_perm_b32 v54, v203, v195, s16
    v_perm_b32 v55, v203, v195, s17
    v_perm_b32 v195, v218, v210, s16
    v_perm_b32 v203, v218, v210, s17
    v_mov_b32 v210, v54
    v_mov_b32 v218, v55
    s_waitcnt lgkmcnt(0)
    v_max3_f32 v56, v58, v59, v60
    v_max_f32 v56, v56, v61
    v_sub_f32 v58, v58, v56
    v_sub_f32 v59, v59, v56
    v_sub_f32 v60, v60, v56
    v_sub_f32 v61, v61, v56
    v_exp_f32 v58, v58
    v_exp_f32 v59, v59
    v_exp_f32 v60, v60
    v_exp_f32 v61, v61
    v_min_u32 v56, -2, v56
    s_waitcnt vmcnt(5)
    v_perm_b32 v54, v172, v164, s16
    v_perm_b32 v172, v172, v164, s17
    v_mov_b32 v164, v54
    v_perm_b32 v44, v175, v167, s16
    v_perm_b32 v48, v175, v167, s17
    v_perm_b32 v54, v189, v181, s16
    v_perm_b32 v189, v189, v181, s17
    v_mov_b32 v181, v54
    v_perm_b32 v45, v191, v183, s16
    v_perm_b32 v49, v191, v183, s17
    v_perm_b32 v54, v206, v198, s16
    v_perm_b32 v206, v206, v198, s17
    v_mov_b32 v198, v54
    v_perm_b32 v46, v207, v199, s16
    v_perm_b32 v50, v207, v199, s17
    v_perm_b32 v54, v173, v165, s16
    v_perm_b32 v55, v173, v165, s17
    v_perm_b32 v165, v188, v180, s16
    v_perm_b32 v173, v188, v180, s17
    v_mov_b32 v180, v54
    v_mov_b32 v188, v55
    v_perm_b32 v54, v174, v166, s16
    v_perm_b32 v55, v174, v166, s17
    v_perm_b32 v166, v204, v196, s16
    v_perm_b32 v174, v204, v196, s17
    v_mov_b32 v196, v54
    v_mov_b32 v204, v55
    v_perm_b32 v54, v190, v182, s16
    v_perm_b32 v55, v190, v182, s17
    v_perm_b32 v182, v205, v197, s16
    v_perm_b32 v190, v205, v197, s17
    v_mov_b32 v197, v54
    v_mov_b32 v205, v55
    s_waitcnt vmcnt(3)
    v_perm_b32 v167, v220, v212, s16
    v_perm_b32 v175, v220, v212, s17
    v_perm_b32 v183, v221, v213, s16
    v_perm_b32 v191, v221, v213, s17
    v_smfmac_f32_16x16x64_bf16 v[64:67], v[40:43], v[160:167], v23
    v_perm_b32 v199, v222, v214, s16
    v_perm_b32 v207, v222, v214, s17
    v_smfmac_f32_16x16x64_bf16 v[68:71], v[40:43], v[168:175], v23
    v_perm_b32 v47, v223, v215, s16
    v_perm_b32 v223, v223, v215, s17
    v_smfmac_f32_16x16x64_bf16 v[72:75], v[40:43], v[176:183], v23
    v_mov_b32 v212, v44
    v_mov_b32 v213, v45
    v_smfmac_f32_16x16x64_bf16 v[76:79], v[40:43], v[184:191], v23
    v_mov_b32 v214, v46
    v_mov_b32 v215, v47
    v_smfmac_f32_16x16x64_bf16 v[80:83], v[40:43], v[192:199], v23
    v_mov_b32 v220, v48
    v_mov_b32 v221, v49
    v_smfmac_f32_16x16x64_bf16 v[84:87], v[40:43], v[200:207], v23
    v_mov_b32 v222, v50
    v_smfmac_f32_16x16x64_bf16 v[88:91], v[40:43], v[208:215], v23
    s_nop 0
    v_smfmac_f32_16x16x64_bf16 v[92:95], v[40:43], v[216:223], v23
    v_add_f32 v44, v64, v65
    v_add_f32 v45, v68, v69
    v_add_f32 v46, v72, v73
    v_add_f32 v47, v76, v77
    v_add_f32 v48, v80, v81
    v_add_f32 v49, v84, v85
    v_add_f32 v50, v88, v89
    s_nop 0
    v_add_f32 v51, v92, v93
    s_mov_b64 exec, s[76:77]
    ds_write_b128 v18, v[44:47]
    ds_write_b128 v18, v[48:51] offset:16
    s_mov_b64 exec, s[20:21]
L_fin:
    s_lshl_b32 s13, s5, 8
    s_add_u32 s13, s13, s6
    s_add_u32 s13, s13, 2048
    s_lshl_b32 s14, s5, 3
    s_add_u32 s14, s14, s6
    s_add_u32 s14, s14, 16384
    s_waitcnt lgkmcnt(0)
    s_barrier
    s_cmp_lg_u32 s3, 0
    s_cbranch_scc1 L_fin_done
    ds_read_b64 v[28:29], v15 offset:0
    ds_read_b64 v[30:31], v15 offset:512
    ds_read_b128 v[36:39], v62 offset:2064
    ds_read_b64 v[32:33], v15 offset:1024
    ds_read_b64 v[34:35], v15 offset:1536
    s_cmp_lg_u32 s9, 0
    s_waitcnt lgkmcnt(4)
    v_mul_f32 v28, v58, v28
    v_mul_f32 v29, v58, v29
    s_waitcnt lgkmcnt(3)
    v_fmac_f32 v28, v59, v30
    v_fmac_f32 v29, v59, v31
    s_waitcnt lgkmcnt(2)
    v_mul_f32 v57, v58, v36
    v_fmac_f32 v57, v59, v37
    s_waitcnt lgkmcnt(1)
    v_fmac_f32 v28, v60, v32
    v_fmac_f32 v29, v60, v33
    v_fmac_f32 v57, v60, v38
    s_waitcnt lgkmcnt(0)
    v_fmac_f32 v28, v61, v34
    v_fmac_f32 v29, v61, v35
    v_fmac_f32 v57, v61, v39
    v_cvt_pk_bf16_f32 v28, v28, v29
    v_min_u32 v57, -2, v57
    v_min_u32 v28, -2, v28
    s_cbranch_scc1 L_slow_36
    buffer_store_dword v28, v13, s[60:63], s13 offen
    s_mov_b64 exec, s[32:33]
    buffer_store_dwordx2 v[56:57], v13, s[60:63], s14 offen
    s_mov_b64 exec, s[20:21]
L_pubd_37:
L_fin_done:
    s_lshl_b32 s13, s3, 11
    s_add_u32 s13, s13, s6
    s_add_u32 s13, s13, 2048
    s_lshl_b32 s14, s3, 6
    s_add_u32 s14, s14, s6
    s_add_u32 s14, s14, 16384
    ds_read_b64_tr_b16 v[64:65], v1 offset:4096
    ds_read_b64_tr_b16 v[66:67], v1 offset:4608
    ds_read_b64_tr_b16 v[68:69], v1 offset:5120
    ds_read_b64_tr_b16 v[70:71], v1 offset:5632
    ds_read_b64_tr_b16 v[72:73], v1 offset:6144
    ds_read_b64_tr_b16 v[74:75], v1 offset:6656
    ds_read_b64_tr_b16 v[76:77], v1 offset:7168
    ds_read_b64_tr_b16 v[78:79], v1 offset:7680
    s_waitcnt lgkmcnt(0)
    s_barrier
    s_cmp_eq_u32 s10, 0
    s_cbranch_scc1 L_sl_38
    s_sleep 1
L_sl_38:
    s_sleep 1
L_poll_39:
    buffer_load_dwordx2 v[36:37], v10, s[60:63], s14 offen sc1
    buffer_load_dwordx4 v[28:31], v9, s[60:63], s13 offen sc1
    buffer_load_dwordx4 v[32:35], v9, s[60:63], s13 offen offset:128 sc1
    s_sub_u32 s11, s11, 1
    s_cbranch_scc1 L_abort
    s_waitcnt vmcnt(0)
    v_mfma_f32_16x16x32_bf16 v[40:43], v[28:31], v[64:67], 0
    v_mfma_f32_16x16x32_bf16 v[40:43], v[32:35], v[72:75], v[40:43]
    v_max_u32 v38, v36, v37
    v_max3_u32 v38, v28, v29, v38
    v_max3_u32 v38, v30, v31, v38
    v_max3_u32 v38, v32, v33, v38
    v_max3_u32 v38, v34, v35, v38
    v_cmp_eq_u32 vcc, -1, v38
    s_cbranch_vccnz L_poll_39
    v_max_f32_dpp v38, v36, v36 quad_perm:[1,0,3,2] row_mask:0xf bank_mask:0xf
    v_mov_b32_dpp v44, v28 row_shl:8 row_mask:0xf bank_mask:0xf
    v_mov_b32_dpp v45, v29 row_shl:8 row_mask:0xf bank_mask:0xf
    v_mov_b32_dpp v46, v30 row_shl:8 row_mask:0xf bank_mask:0xf
    v_mov_b32_dpp v47, v31 row_shl:8 row_mask:0xf bank_mask:0xf
    v_max_f32_dpp v38, v38, v38 quad_perm:[2,3,0,1] row_mask:0xf bank_mask:0xf
    v_mov_b32_dpp v48, v32 row_shl:8 row_mask:0xf bank_mask:0xf
    v_mfma_f32_16x16x32_bf16 v[40:43], v[44:47], v[68:71], v[40:43]
    v_mov_b32_dpp v49, v33 row_shl:8 row_mask:0xf bank_mask:0xf
    v_mov_b32_dpp v50, v34 row_shl:8 row_mask:0xf bank_mask:0xf
    v_mov_b32_dpp v51, v35 row_shl:8 row_mask:0xf bank_mask:0xf
    v_sub_f32 v38, v36, v38
    v_exp_f32 v38, v38
    v_mfma_f32_16x16x32_bf16 v[40:43], v[48:51], v[76:79], v[40:43]
    v_mul_f32 v39, v38, v37
    s_lshl_b32 s13, s4, 7
    s_add_u32 s13, s13, s7
    v_add_f32_dpp v39, v39, v39 quad_perm:[1,0,3,2] row_mask:0xf bank_mask:0xf
    s_nop 1
    v_add_f32_dpp v39, v39, v39 quad_perm:[2,3,0,1] row_mask:0xf bank_mask:0xf
    v_rcp_f32 v39, v39
    s_nop 0
    v_mul_f32 v38, v38, v39
    s_nop 1
    v_mul_f32_dpp v52, v38, v40 quad_perm:[0,0,0,0] row_mask:0xf bank_mask:0xf
    v_fmac_f32_dpp v52, v38, v41 quad_perm:[1,1,1,1] row_mask:0xf bank_mask:0xf
    v_fmac_f32_dpp v52, v38, v42 quad_perm:[2,2,2,2] row_mask:0xf bank_mask:0xf
    v_fmac_f32_dpp v52, v38, v43 quad_perm:[3,3,3,3] row_mask:0xf bank_mask:0xf
    s_mov_b64 exec, s[22:23]
    ds_write_b32 v17, v52 offset:4608
    s_mov_b64 exec, s[20:21]
    s_waitcnt lgkmcnt(0)
    s_barrier
    s_cmp_lg_u32 s3, 0
    s_cbranch_scc1 L_o_done
    ds_read_b128 v[40:43], v16 offset:4608
    s_waitcnt lgkmcnt(0)
    v_pk_add_f32 v[40:41], v[40:41], v[42:43]
    v_add_f32 v40, v40, v41
    v_min_u32 v40, -2, v40
    s_mov_b64 exec, s[22:23]
    buffer_store_dword v40, v13, s[60:63], s13 offen sc1
    s_mov_b64 exec, s[20:21]
L_o_done:
    s_cmp_lg_u32 s10, 0
    s_cbranch_scc1 L_nodma
    v_bfe_u32 v44, v0, 3, 2
    v_lshrrev_b32 v45, 5, v0
    v_lshl_add_u32 v44, v44, 1, v45
    v_bfe_u32 v45, v0, 1, 2
    v_lshl_add_u32 v44, v44, 2, v45
    v_and_b32 v45, 1, v0
    v_lshlrev_b32 v45, 4, v45
    s_movk_i32 s15, 1024
    v_mad_u32_u24 v46, v44, s15, v45
    s_movk_i32 s15, 2752
    v_mad_u32_u24 v47, v44, s15, v45
    s_cmp_eq_u32 s80, 0
    s_cbranch_scc1 L_now1
    s_add_u32 m0, s12, 8192
    s_nop 0
    buffer_load_dwordx4 v47, s[52:55], s67 offen lds
    s_add_u32 s13, s67, 88064
    s_add_u32 m0, s12, 9216
    s_nop 0
    buffer_load_dwordx4 v47, s[52:55], s13 offen lds
    s_add_u32 s13, s67, 176128
    s_add_u32 m0, s12, 10240
    s_nop 0
    buffer_load_dwordx4 v47, s[52:55], s13 offen lds
    s_add_u32 s13, s67, 264192
    s_add_u32 m0, s12, 11264
    s_nop 0
    buffer_load_dwordx4 v47, s[52:55], s13 offen lds
L_now1:
    s_lshl_b32 s14, s3, 11
    s_add_u32 m0, s14, 5120
    s_nop 0
    buffer_load_dwordx4 v46, s[56:59], s66 offen lds
    s_add_u32 s13, s66, 32768
    s_add_u32 m0, s14, 6144
    s_nop 0
    buffer_load_dwordx4 v46, s[56:59], s13 offen lds
L_nodma:
    s_cmp_ge_u32 s70, 32
    s_cbranch_scc1 L_r_done
    s_lshl_b32 s14, s70, 5
    s_add_u32 s13, s14, s6
    s_add_u32 s13, s13, 10496
    v_mov_b32 v80, 0
    v_mov_b32 v81, 0
    v_mov_b32 v82, 0
    v_mov_b32 v83, 0
    v_mov_b32 v84, 0
    v_mov_b32 v85, 0
    v_mov_b32 v86, 0
    v_mov_b32 v87, 0
    s_sleep 8
L_poll_40:
    s_mov_b64 exec, s[22:23]
    buffer_load_dword v80, v13, s[60:63], s71 offen offset:0 sc1
    buffer_load_dword v81, v13, s[60:63], s71 offen offset:128 sc1
    buffer_load_dword v82, v13, s[60:63], s71 offen offset:256 sc1
    buffer_load_dword v83, v13, s[60:63], s71 offen offset:384 sc1
    buffer_load_dword v84, v13, s[60:63], s71 offen offset:512 sc1
    buffer_load_dword v85, v13, s[60:63], s71 offen offset:640 sc1
    buffer_load_dword v86, v13, s[60:63], s71 offen offset:768 sc1
    buffer_load_dword v87, v13, s[60:63], s71 offen offset:896 sc1
    s_mov_b64 exec, s[20:21]
    s_sub_u32 s11, s11, 1
    s_cbranch_scc1 L_abort
    s_waitcnt vmcnt(0)
    v_max_u32 v36, v80, v81
    v_max3_u32 v36, v82, v83, v36
    v_max3_u32 v36, v84, v85, v36
    v_max3_u32 v36, v86, v87, v36
    v_cmp_eq_u32 vcc, -1, v36
    s_cbranch_vccnz L_poll_40
    v_pk_add_f32 v[88:89], v[80:81], v[82:83]
    v_pk_add_f32 v[90:91], v[84:85], v[86:87]
    v_add_f32 v88, v88, v4
    v_pk_add_f32 v[88:89], v[88:89], v[90:91]
    v_add_f32 v88, v88, v89
    s_nop 1
    v_mov_b32_dpp v89, v88 quad_perm:[1,1,3,3] row_mask:0xf bank_mask:0xf
    v_cvt_pk_bf16_f32 v89, v88, v89
    v_min_u32 v89, -2, v89
    s_mov_b64 exec, s[24:25]
    s_cmp_lg_u32 s9, 0
    s_cbranch_scc1 L_slow_41
    buffer_store_dword v89, v6, s[60:63], s13 offen
L_pubd_42:
    s_mov_b64 exec, s[20:21]
    v_cvt_pk_bf16_f32 v4, v88, v88
    v_and_b32 v4, 0xffff0000, v4
L_r_done:
    s_waitcnt vmcnt(0)
    v_mov_b32 v28, 0x3f803f80
    v_mov_b32 v29, 0x3f803f80
    v_mov_b32 v30, 0x3f803f80
    v_mov_b32 v31, 0x3f803f80
    v_mov_b32 v32, 0x3f803f80
    v_mov_b32 v33, 0x3f803f80
    v_mov_b32 v34, 0x3f803f80
    v_mov_b32 v35, 0x3f803f80
    v_mov_b32 v76, 0x3f803f80
    v_mov_b32 v77, 0x3f803f80
    v_mov_b32 v78, 0x3f803f80
    v_mov_b32 v79, 0x3f803f80
    ds_read_b64_tr_b16 v[44:45], v1 offset:8192
    ds_read_b64_tr_b16 v[46:47], v1 offset:8704
    ds_read_b64_tr_b16 v[48:49], v1 offset:9216
    ds_read_b64_tr_b16 v[50:51], v1 offset:9728
    ds_read_b64_tr_b16 v[52:53], v1 offset:10240
    ds_read_b64_tr_b16 v[54:55], v1 offset:10752
    ds_read_b64_tr_b16 v[56:57], v1 offset:11264
    ds_read_b64_tr_b16 v[58:59], v1 offset:11776
    s_lshl_b32 s13, s3, 8
    s_add_u32 s13, s13, s6
    s_add_u32 s13, s13, 10496
    s_waitcnt lgkmcnt(0)
    s_barrier
    s_cmp_eq_u32 s80, 0
    s_cbranch_scc1 L_h_done
L_poll_43:
    s_mov_b64 exec, s[26:27]
    buffer_load_dwordx4 v[28:31], v5, s[60:63], s13 offen sc1
    s_mov_b64 exec, s[20:21]
    s_sub_u32 s11, s11, 1
    s_cbranch_scc1 L_abort
    s_waitcnt vmcnt(0)
    v_mfma_f32_16x16x32_bf16 v[40:43], v[28:31], v[44:47], 0
    v_mfma_f32_16x16x32_bf16 v[36:39], v[28:31], v[28:31], 0
    v_max_u32 v60, v28, v29
    v_max3_u32 v60, v30, v31, v60
    v_cmp_eq_u32 vcc, -1, v60
    s_cbranch_vccnz L_poll_43
    s_sub_u32 s13, s5, 16
    s_lshl_b32 s13, s13, 5
    s_add_u32 s13, s13, s6
    s_add_u32 s13, s13, 14592
    v_mov_b32_dpp v32, v28 row_shl:2 row_mask:0xf bank_mask:0xf
    v_mov_b32_dpp v33, v29 row_shl:2 row_mask:0xf bank_mask:0xf
    v_mov_b32_dpp v34, v30 row_shl:2 row_mask:0xf bank_mask:0xf
    v_mov_b32_dpp v35, v31 row_shl:2 row_mask:0xf bank_mask:0xf
    v_mov_b32_dpp v76, v28 row_shl:4 row_mask:0xf bank_mask:0xf
    v_mov_b32_dpp v77, v29 row_shl:4 row_mask:0xf bank_mask:0xf
    v_mfma_f32_16x16x32_bf16 v[40:43], v[32:35], v[48:51], v[40:43]
    v_mov_b32_dpp v78, v30 row_shl:4 row_mask:0xf bank_mask:0xf
    v_mov_b32_dpp v79, v31 row_shl:4 row_mask:0xf bank_mask:0xf
    v_mfma_f32_16x16x32_bf16 v[36:39], v[32:35], v[32:35], v[36:39]
    v_mov_b32_dpp v32, v28 row_shl:6 row_mask:0xf bank_mask:0xf
    v_mov_b32_dpp v33, v29 row_shl:6 row_mask:0xf bank_mask:0xf
    v_mov_b32_dpp v34, v30 row_shl:6 row_mask:0xf bank_mask:0xf
    v_mov_b32_dpp v35, v31 row_shl:6 row_mask:0xf bank_mask:0xf
    v_mfma_f32_16x16x32_bf16 v[40:43], v[76:79], v[52:55], v[40:43]
    v_mfma_f32_16x16x32_bf16 v[36:39], v[76:79], v[76:79], v[36:39]
    v_mfma_f32_16x16x32_bf16 v[40:43], v[32:35], v[56:59], v[40:43]
    v_mfma_f32_16x16x32_bf16 v[36:39], v[32:35], v[32:35], v[36:39]
    s_mov_b64 exec, s[30:31]
    s_nop 5
    ds_write2st64_b32 v17, v40, v41 offset0:0 offset1:1
    ds_write2st64_b32 v17, v36, v37 offset0:4 offset1:5
    s_mov_b64 exec, s[20:21]
    s_waitcnt lgkmcnt(0)
    s_barrier
    s_cmp_lg_u32 s3, 0
    s_cbranch_scc1 L_h_done
    ds_read_b128 v[68:71], v20 offset:1024
    ds_read_b128 v[72:75], v21 offset:1536
    ds_read_b128 v[60:63], v16
    ds_read_b128 v[64:67], v19 offset:512
    v_mov_b32 v44, s85
    s_waitcnt lgkmcnt(2)
    v_pk_add_f32 v[68:69], v[68:69], v[70:71]
    v_pk_add_f32 v[72:73], v[72:73], v[74:75]
    v_add_f32 v68, v68, v69
    v_add_f32 v72, v72, v73
    v_mul_f32 v72, s84, v72
    v_fma_f32 v68, v68, s84, v44
    v_fma_f32 v68, -v72, v72, v68
    v_max_f32 v68, s85, v68
    v_rsq_f32 v68, v68
    s_waitcnt lgkmcnt(0)
    v_pk_add_f32 v[60:61], v[60:61], v[62:63]
    v_pk_add_f32 v[64:65], v[64:65], v[66:67]
    v_add_f32 v60, v60, v61
    v_add_f32 v64, v64, v65
    v_fma_f32 v60, -v72, v64, v60
    v_fma_f32 v60, v60, v68, v2
    v_mov_b32 v62, s82
    v_mul_f32 v61, v60, v60
    v_fma_f32 v61, v61, s83, v62
    v_mul_f32 v61, v61, v60
    v_exp_f32 v61, v61
    s_nop 0
    v_add_f32 v61, 1.0, v61
    v_rcp_f32 v61, v61
    s_nop 0
    v_mul_f32 v60, v60, v61
    s_nop 1
    v_mov_b32_dpp v61, v60 quad_perm:[1,1,3,3] row_mask:0xf bank_mask:0xf
    v_cvt_pk_bf16_f32 v61, v60, v61
    v_min_u32 v61, -2, v61
    s_mov_b64 exec, s[24:25]
    s_cmp_lg_u32 s9, 0
    s_cbranch_scc1 L_slow_44
    buffer_store_dword v61, v8, s[60:63], s13 offen
L_pubd_45:
    s_mov_b64 exec, s[20:21]
L_h_done:
    s_cmp_lg_u32 s3, 0
    s_cbranch_scc1 L_x2_done
    v_mov_b32 v92, 0
    v_mov_b32 v93, 0
    v_mov_b32 v94, 0
    v_mov_b32 v95, 0
    ds_read_b64_tr_b16 v[44:45], v15 offset:5120
    ds_read_b64_tr_b16 v[46:47], v15 offset:5632
    ds_read_b64_tr_b16 v[48:49], v15 offset:6144
    ds_read_b64_tr_b16 v[50:51], v15 offset:6656
    ds_read_b64_tr_b16 v[52:53], v15 offset:7168
    ds_read_b64_tr_b16 v[54:55], v15 offset:7680
    ds_read_b64_tr_b16 v[56:57], v15 offset:8192
    ds_read_b64_tr_b16 v[58:59], v15 offset:8704
    ds_read_b64_tr_b16 v[60:61], v15 offset:9216
    ds_read_b64_tr_b16 v[62:63], v15 offset:9728
    ds_read_b64_tr_b16 v[64:65], v15 offset:10240
    ds_read_b64_tr_b16 v[66:67], v15 offset:10752
    s_add_u32 s13, s6, 14592
    s_lshl_b32 s14, s81, 10
    s_lshl_b32 s15, s4, 7
    s_add_u32 s14, s14, s15
    s_lshl_b32 s15, s10, 15
    s_add_u32 s14, s14, s15
    s_add_u32 s14, s14, 458752
    s_waitcnt lgkmcnt(0)
L_poll_46:
    s_mov_b64 exec, s[34:35]
    buffer_load_dwordx4 v[92:95], v12, s[60:63], s13 offen sc1
    s_mov_b64 exec, s[20:21]
    s_sub_u32 s11, s11, 1
    s_cbranch_scc1 L_abort
    s_waitcnt vmcnt(0)
    v_mfma_f32_16x16x32_bf16 v[36:39], v[92:95], v[44:47], 0
    v_max_u32 v40, v92, v93
    v_max3_u32 v40, v94, v95, v40
    v_cmp_eq_u32 vcc, -1, v40
    s_cbranch_vccnz L_poll_46
    v_mov_b32_dpp v40, v92 row_shl:2 row_mask:0xf bank_mask:0xf
    v_mov_b32_dpp v41, v93 row_shl:2 row_mask:0xf bank_mask:0xf
    v_mov_b32_dpp v42, v94 row_shl:2 row_mask:0xf bank_mask:0xf
    v_mov_b32_dpp v43, v95 row_shl:2 row_mask:0xf bank_mask:0xf
    v_mov_b32_dpp v32, v92 row_shl:4 row_mask:0xf bank_mask:0xf
    v_mov_b32_dpp v33, v93 row_shl:4 row_mask:0xf bank_mask:0xf
    v_mov_b32_dpp v34, v94 row_shl:4 row_mask:0xf bank_mask:0xf
    v_mov_b32_dpp v35, v95 row_shl:4 row_mask:0xf bank_mask:0xf
    v_mfma_f32_16x16x32_bf16 v[36:39], v[40:43], v[48:51], v[36:39]
    v_mov_b32_dpp v40, v92 row_shl:6 row_mask:0xf bank_mask:0xf
    v_mov_b32_dpp v41, v93 row_shl:6 row_mask:0xf bank_mask:0xf
    v_mov_b32_dpp v42, v94 row_shl:6 row_mask:0xf bank_mask:0xf
    v_mov_b32_dpp v43, v95 row_shl:6 row_mask:0xf bank_mask:0xf
    v_mfma_f32_16x16x32_bf16 v[36:39], v[32:35], v[52:55], v[36:39]
    v_mov_b32_dpp v32, v92 row_shl:8 row_mask:0xf bank_mask:0xf
    v_mov_b32_dpp v33, v93 row_shl:8 row_mask:0xf bank_mask:0xf
    v_mov_b32_dpp v34, v94 row_shl:8 row_mask:0xf bank_mask:0xf
    v_mov_b32_dpp v35, v95 row_shl:8 row_mask:0xf bank_mask:0xf
    v_mfma_f32_16x16x32_bf16 v[36:39], v[40:43], v[56:59], v[36:39]
    v_mov_b32_dpp v40, v92 row_shl:10 row_mask:0xf bank_mask:0xf
    v_mov_b32_dpp v41, v93 row_shl:10 row_mask:0xf bank_mask:0xf
    v_mov_b32_dpp v42, v94 row_shl:10 row_mask:0xf bank_mask:0xf
    v_mov_b32_dpp v43, v95 row_shl:10 row_mask:0xf bank_mask:0xf
    v_mfma_f32_16x16x32_bf16 v[36:39], v[32:35], v[60:63], v[36:39]
    s_nop 0
    v_mfma_f32_16x16x32_bf16 v[36:39], v[40:43], v[64:67], v[36:39]
    s_mov_b64 exec, s[76:77]
    s_nop 6
    v_min_u32 v36, -2, v36
    v_min_u32 v37, -2, v37
    buffer_store_dwordx2 v[36:37], v15, s[60:63], s14 offen sc1
    s_mov_b64 exec, s[20:21]
L_x2_done:
    s_barrier
    s_mul_i32 s13, s10, s4
    s_cmp_lg_u32 s13, 0
    s_cbranch_scc1 L_abort
    s_cmp_ge_u32 s70, 32
    s_cbranch_scc1 L_r2_done
    s_lshl_b32 s14, s70, 5
    s_add_u32 s13, s14, s6
    s_add_u32 s13, s13, 12544
    v_mov_b32 v80, 0
    v_mov_b32 v81, 0
    v_mov_b32 v82, 0
    v_mov_b32 v83, 0
    v_mov_b32 v84, 0
    v_mov_b32 v85, 0
    v_mov_b32 v86, 0
    v_mov_b32 v87, 0
    v_add_f32 v4, v4, v3
    s_add_u32 s15, s71, 65536
    s_cmp_eq_u32 s10, 1
    s_cbranch_scc1 L_sl_47
    s_sleep 5
L_sl_47:
    s_sleep 6
L_poll_48:
    s_mov_b64 exec, s[22:23]
    buffer_load_dword v80, v14, s[60:63], s15 offen offset:0 sc1
    buffer_load_dword v81, v14, s[60:63], s15 offen offset:128 sc1
    buffer_load_dword v82, v14, s[60:63], s15 offen offset:256 sc1
    buffer_load_dword v83, v14, s[60:63], s15 offen offset:384 sc1
    buffer_load_dword v84, v14, s[60:63], s15 offen offset:512 sc1
    buffer_load_dword v85, v14, s[60:63], s15 offen offset:640 sc1
    buffer_load_dword v86, v14, s[60:63], s15 offen offset:768 sc1
    buffer_load_dword v87, v14, s[60:63], s15 offen offset:896 sc1
    s_mov_b64 exec, s[20:21]
    s_sub_u32 s11, s11, 1
    s_cbranch_scc1 L_abort
    s_waitcnt vmcnt(0)
    v_max_u32 v36, v80, v81
    v_max3_u32 v36, v82, v83, v36
    v_max3_u32 v36, v84, v85, v36
    v_max3_u32 v36, v86, v87, v36
    v_cmp_eq_u32 vcc, -1, v36
    s_cbranch_vccnz L_poll_48
    v_pk_add_f32 v[88:89], v[80:81], v[82:83]
    v_pk_add_f32 v[90:91], v[84:85], v[86:87]
    v_add_f32 v88, v88, v4
    v_pk_add_f32 v[88:89], v[88:89], v[90:91]
    v_add_f32 v88, v88, v89
    s_nop 1
    v_mov_b32_dpp v89, v88 quad_perm:[1,1,3,3] row_mask:0xf bank_mask:0xf
    v_cvt_pk_bf16_f32 v89, v88, v89
    v_min_u32 v89, -2, v89
    s_mov_b64 exec, s[24:25]
    s_cmp_lg_u32 s10, 0
    s_cbranch_scc1 L_final
    s_cmp_lg_u32 s9, 0
    s_cbranch_scc1 L_slow_49
    buffer_store_dword v89, v6, s[60:63], s13 offen
L_pubd_50:
    s_mov_b64 exec, s[20:21]
    v_cvt_pk_bf16_f32 v4, v88, v88
    v_and_b32 v4, 0xffff0000, v4
L_r2_done:
    s_cmp_lg_u32 s10, 0
    s_cbranch_scc1 L_abort
    v_mov_b32 v28, 0x3f803f80
    v_mov_b32 v29, 0x3f803f80
    v_mov_b32 v30, 0x3f803f80
    v_mov_b32 v31, 0x3f803f80
    v_mov_b32 v32, 0x3f803f80
    v_mov_b32 v33, 0x3f803f80
    v_mov_b32 v34, 0x3f803f80
    v_mov_b32 v35, 0x3f803f80
    v_mov_b32 v76, 0x3f803f80
    v_mov_b32 v77, 0x3f803f80
    v_mov_b32 v78, 0x3f803f80
    v_mov_b32 v79, 0x3f803f80
    ds_read_b64_tr_b16 v[44:45], v1 offset:0
    ds_read_b64_tr_b16 v[46:47], v1 offset:512
    ds_read_b64_tr_b16 v[48:49], v1 offset:1024
    ds_read_b64_tr_b16 v[50:51], v1 offset:1536
    ds_read_b64_tr_b16 v[52:53], v1 offset:2048
    ds_read_b64_tr_b16 v[54:55], v1 offset:2560
    ds_read_b64_tr_b16 v[56:57], v1 offset:3072
    ds_read_b64_tr_b16 v[58:59], v1 offset:3584
    s_lshl_b32 s86, s3, 8
    s_add_u32 s86, s86, s6
    s_add_u32 s86, s86, 12544
    s_mov_b32 s10, 1
    s_add_u32 s6, s6, 24576
    s_add_u32 s7, s7, 32768
    s_add_u32 s71, s71, 32768
    s_lshr_b32 s13, s5, 3
    s_lshl_b32 s13, s13, 9
    s_and_b32 s14, s5, 7
    s_lshl_b32 s14, s14, 5
    s_add_u32 s13, s13, s14
    s_add_u32 s13, s13, s6
    s_lshr_b32 s89, s5, 2
    s_lshl_b32 s89, s89, 8
    s_add_u32 s89, s89, s6
    s_waitcnt lgkmcnt(0)
    s_barrier
L_poll_51:
    s_mov_b64 exec, s[26:27]
    buffer_load_dwordx4 v[28:31], v5, s[60:63], s86 offen sc1
    s_mov_b64 exec, s[20:21]
    s_sub_u32 s11, s11, 1
    s_cbranch_scc1 L_abort
    s_waitcnt vmcnt(0)
    v_mfma_f32_16x16x32_bf16 v[40:43], v[28:31], v[44:47], 0
    v_mfma_f32_16x16x32_bf16 v[36:39], v[28:31], v[28:31], 0
    v_max_u32 v60, v28, v29
    v_max3_u32 v60, v30, v31, v60
    v_cmp_eq_u32 vcc, -1, v60
    s_cbranch_vccnz L_poll_51
    v_mov_b32_dpp v32, v28 row_shl:2 row_mask:0xf bank_mask:0xf
    v_mov_b32_dpp v33, v29 row_shl:2 row_mask:0xf bank_mask:0xf
    v_mov_b32_dpp v34, v30 row_shl:2 row_mask:0xf bank_mask:0xf
    v_mov_b32_dpp v35, v31 row_shl:2 row_mask:0xf bank_mask:0xf
    v_mov_b32_dpp v76, v28 row_shl:4 row_mask:0xf bank_mask:0xf
    v_mov_b32_dpp v77, v29 row_shl:4 row_mask:0xf bank_mask:0xf
    v_mfma_f32_16x16x32_bf16 v[40:43], v[32:35], v[48:51], v[40:43]
    v_mov_b32_dpp v78, v30 row_shl:4 row_mask:0xf bank_mask:0xf
    v_mov_b32_dpp v79, v31 row_shl:4 row_mask:0xf bank_mask:0xf
    v_mfma_f32_16x16x32_bf16 v[36:39], v[32:35], v[32:35], v[36:39]
    v_mov_b32_dpp v32, v28 row_shl:6 row_mask:0xf bank_mask:0xf
    v_mov_b32_dpp v33, v29 row_shl:6 row_mask:0xf bank_mask:0xf
    v_mov_b32_dpp v34, v30 row_shl:6 row_mask:0xf bank_mask:0xf
    v_mov_b32_dpp v35, v31 row_shl:6 row_mask:0xf bank_mask:0xf
    v_mfma_f32_16x16x32_bf16 v[40:43], v[76:79], v[52:55], v[40:43]
    v_mfma_f32_16x16x32_bf16 v[36:39], v[76:79], v[76:79], v[36:39]
    v_mfma_f32_16x16x32_bf16 v[40:43], v[32:35], v[56:59], v[40:43]
    v_mfma_f32_16x16x32_bf16 v[36:39], v[32:35], v[32:35], v[36:39]
    s_mov_b64 exec, s[30:31]
    s_nop 5
    ds_write2st64_b32 v17, v40, v41 offset0:0 offset1:1
    ds_write2st64_b32 v17, v36, v37 offset0:4 offset1:5
    s_mov_b64 exec, s[20:21]
    s_waitcnt lgkmcnt(0)
    s_barrier
    s_cmp_lg_u32 s3, 0
    s_cbranch_scc1 L_q2_done
    ds_read_b128 v[68:71], v20 offset:1024
    ds_read_b128 v[72:75], v21 offset:1536
    ds_read_b128 v[60:63], v16
    ds_read_b128 v[64:67], v19 offset:512
    v_mov_b32 v44, s85
    s_waitcnt lgkmcnt(2)
    v_pk_add_f32 v[68:69], v[68:69], v[70:71]
    v_pk_add_f32 v[72:73], v[72:73], v[74:75]
    v_add_f32 v68, v68, v69
    v_add_f32 v72, v72, v73
    v_mul_f32 v72, s84, v72
    v_fma_f32 v68, v68, s84, v44
    v_fma_f32 v68, -v72, v72, v68
    v_max_f32 v68, s85, v68
    v_rsq_f32 v68, v68
    s_waitcnt lgkmcnt(0)
    v_pk_add_f32 v[60:61], v[60:61], v[62:63]
    v_pk_add_f32 v[64:65], v[64:65], v[66:67]
    v_add_f32 v60, v60, v61
    v_add_f32 v64, v64, v65
    v_fma_f32 v60, -v72, v64, v60
    v_mul_f32 v60, v60, v68
    s_nop 1
    v_mov_b32_dpp v61, v60 quad_perm:[1,1,3,3] row_mask:0xf bank_mask:0xf
    v_cvt_pk_bf16_f32 v61, v60, v61
    v_min_u32 v61, -2, v61
    s_mov_b64 exec, s[24:25]
    s_cmp_lg_u32 s9, 0
    s_cbranch_scc1 L_slow_52
    buffer_store_dword v61, v7, s[60:63], s13 offen
L_pubd_53:
    s_mov_b64 exec, s[20:21]
L_q2_done:
    v_mov_b32 v28, 0
    v_mov_b32 v29, 0
    v_mov_b32 v30, 0
    v_mov_b32 v31, 0
    v_mov_b32 v48, 0
    v_mov_b32 v49, 0
    v_mov_b32 v52, 0
    v_mov_b32 v53, 0
    v_mov_b32 v56, 0
    v_mov_b32 v57, 0
    v_mov_b32 v60, 0
    v_mov_b32 v61, 0
    v_mov_b32 v64, 0
    v_mov_b32 v65, 0
    v_mov_b32 v68, 0
    v_mov_b32 v69, 0
    v_mov_b32 v72, 0
    v_mov_b32 v73, 0
    v_mov_b32 v76, 0
    v_mov_b32 v77, 0
    v_mov_b32 v80, 0
    v_mov_b32 v81, 0
    v_mov_b32 v84, 0
    v_mov_b32 v85, 0
    v_mov_b32 v88, 0
    v_mov_b32 v89, 0
    v_mov_b32 v92, 0
    v_mov_b32 v93, 0
    s_barrier
L_poll_54:
    s_mov_b64 exec, s[28:29]
    buffer_load_dwordx4 v[28:31], v11, s[60:63], s89 offen sc1
    s_mov_b64 exec, s[20:21]
    s_sub_u32 s11, s11, 1
    s_cbranch_scc1 L_abort
    s_waitcnt vmcnt(0)
    v_max_u32 v32, v28, v29
    v_max3_u32 v32, v30, v31, v32
    v_cmp_eq_u32 vcc, -1, v32
    s_cbranch_vccnz L_poll_54
    v_and_b32_dpp v32, v28, v26 quad_perm:[0,1,0,0] row_mask:0xf bank_mask:0xf
    v_and_b32_dpp v33, v29, v26 quad_perm:[0,1,0,0] row_mask:0xf bank_mask:0xf
    v_and_b32_dpp v34, v30, v26 quad_perm:[0,1,0,0] row_mask:0xf bank_mask:0xf
    v_and_b32_dpp v35, v31, v26 quad_perm:[0,1,0,0] row_mask:0xf bank_mask:0xf
    s_nop 1
    v_smfmac_f32_16x16x64_bf16 v[48:51], v[32:35], a[0:7], v23
    v_and_b32_dpp v36, v28, v26 quad_perm:[2,3,0,0] row_mask:0xf bank_mask:0xf
    v_and_b32_dpp v37, v29, v26 quad_perm:[2,3,0,0] row_mask:0xf bank_mask:0xf
    v_smfmac_f32_16x16x64_bf16 v[52:55], v[32:35], a[16:23], v23
    v_and_b32_dpp v38, v30, v26 quad_perm:[2,3,0,0] row_mask:0xf bank_mask:0xf
    v_and_b32_dpp v39, v31, v26 quad_perm:[2,3,0,0] row_mask:0xf bank_mask:0xf
    v_smfmac_f32_16x16x64_bf16 v[56:59], v[32:35], a[128:135], v23
    v_smfmac_f32_16x16x64_bf16 v[60:63], v[32:35], a[144:151], v23
    v_smfmac_f32_16x16x64_bf16 v[48:51], v[36:39], a[8:15], v23
    v_mov_b32_dpp v40, v32 row_shr:4 row_mask:0xf bank_mask:0xf bound_ctrl:0
    v_mov_b32_dpp v41, v33 row_shr:4 row_mask:0xf bank_mask:0xf bound_ctrl:0
    v_smfmac_f32_16x16x64_bf16 v[52:55], v[36:39], a[24:31], v23
    v_mov_b32_dpp v42, v34 row_shr:4 row_mask:0xf bank_mask:0xf bound_ctrl:0
    v_mov_b32_dpp v43, v35 row_shr:4 row_mask:0xf bank_mask:0xf bound_ctrl:0
    v_smfmac_f32_16x16x64_bf16 v[56:59], v[36:39], a[136:143], v23
    v_smfmac_f32_16x16x64_bf16 v[60:63], v[36:39], a[152:159], v23
    v_smfmac_f32_16x16x64_bf16 v[48:51], v[40:43], a[32:39], v23
    v_mov_b32_dpp v44, v36 row_shr:4 row_mask:0xf bank_mask:0xf bound_ctrl:0
    v_mov_b32_dpp v45, v37 row_shr:4 row_mask:0xf bank_mask:0xf bound_ctrl:0
    v_smfmac_f32_16x16x64_bf16 v[52:55], v[40:43], a[48:55], v23
    v_mov_b32_dpp v46, v38 row_shr:4 row_mask:0xf bank_mask:0xf bound_ctrl:0
    v_mov_b32_dpp v47, v39 row_shr:4 row_mask:0xf bank_mask:0xf bound_ctrl:0
    v_smfmac_f32_16x16x64_bf16 v[56:59], v[40:43], a[160:167], v23
    ds_read_b128 a[0:3], v22 offset:12288
    ds_read_b128 a[4:7], v22 offset:13312
    v_smfmac_f32_16x16x64_bf16 v[60:63], v[40:43], a[176:183], v23
    ds_read_b128 a[8:11], v22 offset:14336
    ds_read_b128 a[12:15], v22 offset:15360
    v_smfmac_f32_16x16x64_bf16 v[48:51], v[44:47], a[40:47], v23
    v_mov_b32_dpp v40, v32 row_shr:8 row_mask:0xf bank_mask:0xf bound_ctrl:0
    v_mov_b32_dpp v41, v33 row_shr:8 row_mask:0xf bank_mask:0xf bound_ctrl:0
    v_smfmac_f32_16x16x64_bf16 v[52:55], v[44:47], a[56:63], v23
    v_mov_b32_dpp v42, v34 row_shr:8 row_mask:0xf bank_mask:0xf bound_ctrl:0
    v_mov_b32_dpp v43, v35 row_shr:8 row_mask:0xf bank_mask:0xf bound_ctrl:0
    v_smfmac_f32_16x16x64_bf16 v[56:59], v[44:47], a[168:175], v23
    ds_read_b128 a[16:19], v22 offset:16384
    ds_read_b128 a[20:23], v22 offset:17408
    v_smfmac_f32_16x16x64_bf16 v[60:63], v[44:47], a[184:191], v23
    ds_read_b128 a[24:27], v22 offset:18432
    ds_read_b128 a[28:31], v22 offset:19456
    v_smfmac_f32_16x16x64_bf16 v[48:51], v[40:43], a[64:71], v23
    v_mov_b32_dpp v44, v36 row_shr:8 row_mask:0xf bank_mask:0xf bound_ctrl:0
    v_mov_b32_dpp v45, v37 row_shr:8 row_mask:0xf bank_mask:0xf bound_ctrl:0
    v_smfmac_f32_16x16x64_bf16 v[52:55], v[40:43], a[80:87], v23
    v_mov_b32_dpp v46, v38 row_shr:8 row_mask:0xf bank_mask:0xf bound_ctrl:0
    v_mov_b32_dpp v47, v39 row_shr:8 row_mask:0xf bank_mask:0xf bound_ctrl:0
    v_smfmac_f32_16x16x64_bf16 v[56:59], v[40:43], a[192:199], v23
    ds_read_b128 a[128:131], v22 offset:20480
    ds_read_b128 a[132:135], v22 offset:21504
    v_smfmac_f32_16x16x64_bf16 v[60:63], v[40:43], a[208:215], v23
    ds_read_b128 a[136:139], v22 offset:22528
    ds_read_b128 a[140:143], v22 offset:23552
    v_smfmac_f32_16x16x64_bf16 v[48:51], v[44:47], a[72:79], v23
    v_mov_b32_dpp v40, v32 row_shr:12 row_mask:0xf bank_mask:0xf bound_ctrl:0
    v_mov_b32_dpp v41, v33 row_shr:12 row_mask:0xf bank_mask:0xf bound_ctrl:0
    v_smfmac_f32_16x16x64_bf16 v[52:55], v[44:47], a[88:95], v23
    v_mov_b32_dpp v42, v34 row_shr:12 row_mask:0xf bank_mask:0xf bound_ctrl:0
    v_mov_b32_dpp v43, v35 row_shr:12 row_mask:0xf bank_mask:0xf bound_ctrl:0
    v_smfmac_f32_16x16x64_bf16 v[56:59], v[44:47], a[200:207], v23
    ds_read_b128 a[144:147], v22 offset:24576
    ds_read_b128 a[148:151], v22 offset:25600
    v_smfmac_f32_16x16x64_bf16 v[60:63], v[44:47], a[216:223], v23
    ds_read_b128 a[152:155], v22 offset:26624
    ds_read_b128 a[156:159], v22 offset:27648
    v_smfmac_f32_16x16x64_bf16 v[48:51], v[40:43], a[96:103], v23
    v_mov_b32_dpp v44, v36 row_shr:12 row_mask:0xf bank_mask:0xf bound_ctrl:0
    v_mov_b32_dpp v45, v37 row_shr:12 row_mask:0xf bank_mask:0xf bound_ctrl:0
    v_smfmac_f32_16x16x64_bf16 v[52:55], v[40:43], a[112:119], v23
    v_mov_b32_dpp v46, v38 row_shr:12 row_mask:0xf bank_mask:0xf bound_ctrl:0
    v_mov_b32_dpp v47, v39 row_shr:12 row_mask:0xf bank_mask:0xf bound_ctrl:0
    v_smfmac_f32_16x16x64_bf16 v[56:59], v[40:43], a[224:231], v23
    ds_read_b128 a[32:35], v22 offset:28672
    ds_read_b128 a[36:39], v22 offset:29696
    v_smfmac_f32_16x16x64_bf16 v[60:63], v[40:43], a[240:247], v23
    ds_read_b128 a[40:43], v22 offset:30720
    ds_read_b128 a[44:47], v22 offset:31744
    v_smfmac_f32_16x16x64_bf16 v[48:51], v[44:47], a[104:111], v23
    v_smfmac_f32_16x16x64_bf16 v[52:55], v[44:47], a[120:127], v23
    v_smfmac_f32_16x16x64_bf16 v[56:59], v[44:47], a[232:239], v23
    ds_read_b128 a[48:51], v22 offset:32768
    ds_read_b128 a[52:55], v22 offset:33792
    v_smfmac_f32_16x16x64_bf16 v[60:63], v[44:47], a[248:255], v23
    ds_read_b128 a[56:59], v22 offset:34816
    ds_read_b128 a[60:63], v22 offset:35840
    s_nop 0
    v_add_f32 v48, v48, v49
    v_add_f32 v49, v52, v53
    v_add_f32 v50, v56, v57
    s_nop 1
    v_add_f32 v51, v60, v61
    v_max_f32 v56, v48, v49
    v_max3_f32 v56, v50, v51, v56
    s_nop 1
    v_max_f32_dpp v56, v56, v56 quad_perm:[1,0,3,2] row_mask:0xf bank_mask:0xf
    s_nop 1
    v_max_f32_dpp v56, v56, v56 quad_perm:[2,3,0,1] row_mask:0xf bank_mask:0xf
    s_nop 1
    v_max_f32_dpp v56, v56, v56 row_ror:4 row_mask:0xf bank_mask:0xf
    s_nop 1
    v_max_f32_dpp v56, v56, v56 row_ror:8 row_mask:0xf bank_mask:0xf
    v_mov_b32 v57, v56
    s_nop 1
    v_permlane32_swap_b32 v57, v56
    v_max_f32 v56, v56, v57
    v_mov_b32 v57, v56
    s_nop 1
    v_permlane16_swap_b32 v57, v56
    v_max_f32 v56, v56, v57
    v_mul_f32 v56, s78, v56
    v_fma_f32 v48, v48, s78, -v56
    v_fma_f32 v49, v49, s78, -v56
    v_fma_f32 v50, v50, s78, -v56
    v_fma_f32 v51, v51, s78, -v56
    v_exp_f32 v48, v48
    v_exp_f32 v49, v49
    v_exp_f32 v50, v50
    v_exp_f32 v51, v51
    v_cvt_pk_bf16_f32 v52, v48, v49
    v_cvt_pk_bf16_f32 v53, v50, v51
    ds_write2_b32 v24, v52, v53 offset0:0 offset1:64
    s_mov_b64 exec, s[32:33]
    ds_write_b32 v17, v56 offset:2048
    s_mov_b64 exec, s[20:21]
    v_pk_add_f32 v[48:49], v[48:49], v[50:51]
    v_add_f32 v57, v48, v49
    v_mov_b32 v62, 0
    s_waitcnt lgkmcnt(0)
    s_barrier
    ds_read_b128 v[36:39], v25 offset:256
    ds_read_b128 v[40:43], v25 offset:384
    ds_read_b128 v[28:31], v25 offset:0
    ds_read_b128 v[32:35], v25 offset:128
    ds_read_b128 v[58:61], v62 offset:2048
    s_waitcnt lgkmcnt(4)
    v_smfmac_f32_16x16x64_bf16 v[64:67], v[36:39], v[96:103], v23
    v_add_f32_dpp v57, v57, v57 quad_perm:[1,0,3,2] row_mask:0xf bank_mask:0xf
    v_smfmac_f32_16x16x64_bf16 v[68:71], v[36:39], v[104:111], v23
    s_nop 0
    v_add_f32_dpp v57, v57, v57 quad_perm:[2,3,0,1] row_mask:0xf bank_mask:0xf
    v_smfmac_f32_16x16x64_bf16 v[72:75], v[36:39], v[112:119], v23
    s_nop 0
    v_add_f32_dpp v57, v57, v57 row_ror:4 row_mask:0xf bank_mask:0xf
    v_smfmac_f32_16x16x64_bf16 v[76:79], v[36:39], v[120:127], v23
    s_nop 0
    v_add_f32_dpp v57, v57, v57 row_ror:8 row_mask:0xf bank_mask:0xf
    v_smfmac_f32_16x16x64_bf16 v[80:83], v[36:39], v[128:135], v23
    v_mov_b32 v63, v57
    v_smfmac_f32_16x16x64_bf16 v[84:87], v[36:39], v[136:143], v23
    s_nop 0
    v_permlane32_swap_b32 v63, v57
    v_smfmac_f32_16x16x64_bf16 v[88:91], v[36:39], v[144:151], v23
    v_add_f32 v57, v57, v63
    v_smfmac_f32_16x16x64_bf16 v[92:95], v[36:39], v[152:159], v23
    v_mov_b32 v63, v57
    s_waitcnt lgkmcnt(3)
    v_smfmac_f32_16x16x64_bf16 v[64:67], v[40:43], v[160:167], v23
    v_permlane16_swap_b32 v63, v57
    v_smfmac_f32_16x16x64_bf16 v[68:71], v[40:43], v[168:175], v23
    v_add_f32 v57, v57, v63
    v_smfmac_f32_16x16x64_bf16 v[72:75], v[40:43], v[176:183], v23
    v_smfmac_f32_16x16x64_bf16 v[76:79], v[40:43], v[184:191], v23
    v_smfmac_f32_16x16x64_bf16 v[80:83], v[40:43], v[192:199], v23
    v_smfmac_f32_16x16x64_bf16 v[84:87], v[40:43], v[200:207], v23
    v_smfmac_f32_16x16x64_bf16 v[88:91], v[40:43], v[208:215], v23
    v_smfmac_f32_16x16x64_bf16 v[92:95], v[40:43], v[216:223], v23
    s_mov_b64 exec, s[32:33]
    ds_write_b32 v17, v57 offset:2064
    s_mov_b64 exec, s[20:21]
    s_waitcnt lgkmcnt(3)
    s_waitcnt lgkmcnt(1)
    v_smfmac_f32_16x16x64_bf16 v[64:67], v[28:31], a[0:7], v23
    v_max3_f32 v56, v58, v59, v60
    v_smfmac_f32_16x16x64_bf16 v[68:71], v[28:31], a[8:15], v23
    v_max_f32 v56, v56, v61
    v_smfmac_f32_16x16x64_bf16 v[72:75], v[28:31], a[16:23], v23
    v_sub_f32 v58, v58, v56
    v_smfmac_f32_16x16x64_bf16 v[76:79], v[28:31], a[24:31], v23
    v_sub_f32 v59, v59, v56
    v_smfmac_f32_16x16x64_bf16 v[80:83], v[28:31], a[128:135], v23
    v_sub_f32 v60, v60, v56
    v_smfmac_f32_16x16x64_bf16 v[84:87], v[28:31], a[136:143], v23
    v_sub_f32 v61, v61, v56
    v_smfmac_f32_16x16x64_bf16 v[88:91], v[28:31], a[144:151], v23
    v_exp_f32 v58, v58
    v_smfmac_f32_16x16x64_bf16 v[92:95], v[28:31], a[152:159], v23
    v_exp_f32 v59, v59
    s_waitcnt lgkmcnt(2)
    v_smfmac_f32_16x16x64_bf16 v[64:67], v[32:35], a[32:39], v23
    v_exp_f32 v60, v60
    v_smfmac_f32_16x16x64_bf16 v[68:71], v[32:35], a[40:47], v23
    v_exp_f32 v61, v61
    v_smfmac_f32_16x16x64_bf16 v[72:75], v[32:35], a[48:55], v23
    v_min_u32 v56, -2, v56
    v_smfmac_f32_16x16x64_bf16 v[76:79], v[32:35], a[56:63], v23
    v_smfmac_f32_16x16x64_bf16 v[80:83], v[32:35], v[224:231], v23
    v_smfmac_f32_16x16x64_bf16 v[84:87], v[32:35], v[232:239], v23
    v_smfmac_f32_16x16x64_bf16 v[88:91], v[32:35], v[240:247], v23
    v_smfmac_f32_16x16x64_bf16 v[92:95], v[32:35], v[248:255], v23
    v_add_f32 v44, v64, v65
    v_add_f32 v45, v68, v69
    v_add_f32 v46, v72, v73
    s_nop 0
    v_add_f32 v47, v76, v77
    v_add_f32 v48, v80, v81
    v_add_f32 v49, v84, v85
    v_add_f32 v50, v88, v89
    v_add_f32 v51, v92, v93
    s_mov_b64 exec, s[76:77]
    ds_write_b128 v18, v[44:47]
    ds_write_b128 v18, v[48:51] offset:16
    s_mov_b64 exec, s[20:21]
    s_branch L_fin
L_final:
    buffer_store_dword v89, v6, s[72:75], s14 offen
    s_cmp_lg_u32 s70, 0
    s_cbranch_scc1 L_noepo
    v_mov_b32 v30, s79
    s_mov_b32 s13, 657408
    s_mov_b64 exec, 1
    buffer_store_dword v30, v13, s[60:63], s13 offen
L_noepo:
    s_endpgm
L_slow_1:
    buffer_store_dword v27, v7, s[60:63], s13 offen sc1
    s_branch L_pubd_2
L_slow_36:
    buffer_store_dword v28, v13, s[60:63], s13 offen sc1
    s_mov_b64 exec, s[32:33]
    buffer_store_dwordx2 v[56:57], v13, s[60:63], s14 offen sc1
    s_mov_b64 exec, s[20:21]
    s_branch L_pubd_37
L_slow_41:
    buffer_store_dword v89, v6, s[60:63], s13 offen sc1
    s_branch L_pubd_42
L_slow_44:
    buffer_store_dword v61, v8, s[60:63], s13 offen sc1
    s_branch L_pubd_45
L_slow_49:
    buffer_store_dword v89, v6, s[60:63], s13 offen sc1
    s_branch L_pubd_50
L_slow_52:
    buffer_store_dword v61, v7, s[60:63], s13 offen sc1
    s_branch L_pubd_53
L_abort:
L_exit:
    s_endpgm
.section .rodata,"a"
.p2align 6
.amdhsa_kernel interleave_layers__gqa_block_cached__dense_activation_gelu__decode_kernel
  .amdhsa_next_free_vgpr 512
  .amdhsa_next_free_sgpr 102
  .amdhsa_accum_offset 256
  .amdhsa_group_segment_fixed_size 0
  .amdhsa_kernarg_size 104
  .amdhsa_user_sgpr_count 2
  .amdhsa_user_sgpr_kernarg_segment_ptr 1
  .amdhsa_system_sgpr_workgroup_id_x 1
.end_amdhsa_kernel
```
